```python
import torch

def _softmax(x, axis=-1):
    return torch.softmax(x, dim=axis)
def _gelu(x):
    return torch.nn.functional.gelu(x, approximate="tanh")
def _silu(x):
    return torch.nn.functional.silu(x)
def _sigmoid(x):
    return torch.sigmoid(x)
def _layernorm(x, axis=-1, eps=1e-5):
    m = x.mean(dim=axis, keepdim=True)
    v = x.var(dim=axis, keepdim=True, unbiased=False)
    return (x - m) / torch.sqrt(v + eps)
def _scatter_add(tgt, idx, src, axis=0):
    return tgt.clone().index_add_(axis, idx, src)
def _segment_sum(src, seg, n):
    out = torch.zeros((n,) + src.shape[1:], dtype=src.dtype)
    return out.index_add_(0, seg, src)
def _pad(x, pw):
    flat = tuple(v for pair in reversed(pw) for v in pair)
    return torch.nn.functional.pad(x, flat)

kernel_name = 'standalone__paged_block_table_kv_radixattention__sampling'

def setup_inputs():

    _w = (lambda a: (lambda t: t.to(torch.bfloat16) if t.is_floating_point() else t)(torch.as_tensor(a)))
    B, H, Hkv, Dh = 16, 32, 8, 128
    Lk = 4096
    bs = 16
    nb = max(2, Lk // bs)
    P = max(1, nb // 2)
    n_phys = P + B * (nb - P)
    shared = torch.arange(P, dtype=torch.int64)
    priv = P + torch.arange(B * (nb - P), dtype=torch.int64).reshape(B, nb - P)
    bt = torch.cat([torch.tile(shared[None, :], (B, 1)), priv], dim=1)
    ctx = nb * bs - (torch.arange(1, B + 1, dtype=torch.int64) * 2654435761) % max(1, (nb * bs - P * bs) // 2)
    return {
        "q": _w((lambda *s: torch.randn(*s, dtype=torch.bfloat16) * 0.8)(B, H, Dh)),
        "k_cache": _w((lambda *s: torch.randn(*s, dtype=torch.bfloat16) * 0.8)(n_phys, bs, Hkv, Dh)),
        "v_cache": _w((lambda *s: torch.randn(*s, dtype=torch.bfloat16) * 0.05)(n_phys, bs, Hkv, Dh)),
        "block_table": _w(bt.to(torch.int64)),
        "ctx_lens": _w(torch.as_tensor(ctx).to(torch.int64)),
    }

def reference(q, k_cache, v_cache, block_table, ctx_lens):
    B, H, Dh = q.shape
    n_phys, bs, Hkv, _ = k_cache.shape
    nb = block_table.shape[1]
    Lk = nb * bs
    rep = H // Hkv
    k = k_cache[block_table].reshape(B, Lk, Hkv, Dh)
    v = v_cache[block_table].reshape(B, Lk, Hkv, Dh)
    k = (lambda x, n, axis: torch.repeat_interleave(x, n, dim=axis))(k, rep, axis=2)
    v = (lambda x, n, axis: torch.repeat_interleave(x, n, dim=axis))(v, rep, axis=2)
    scores = torch.einsum("bhd,bkhd->bhk", q, k) * (Dh ** -0.5)
    pos = torch.arange(Lk)
    valid = pos[None, :] < ctx_lens[:, None]
    scores = torch.where(valid[:, None, :], scores, -1e9)
    p = _softmax(scores, axis=-1)
    return torch.einsum("bhk,bkhd->bhd", p, v)
```

```asm
; @launch grid=(256,1,1) block=(256,1,1) lds=139264
.amdgcn_target "amdgcn-amd-amdhsa--gfx950"
.text
.globl standalone__paged_block_table_kv_radixattention__sampling_kernel
.p2align 8
.type standalone__paged_block_table_kv_radixattention__sampling_kernel,@function
standalone__paged_block_table_kv_radixattention__sampling_kernel:
    s_load_dwordx16 s[4:19], s[0:1], 0
    s_cmp_ge_u32 s2, 256
    s_cbranch_scc1 L_end
    s_getpc_b64 s[78:79]
L_pc0:
    s_bfe_u32 s53, s2, 0x30003
    s_lshl_b32 s53, s53, 12
    v_lshl_add_u32 v23, v0, 4, s53
    v_min_u32 v23, L_end-L_pc0-16, v23
    global_load_dwordx4 v[236:239], v23, s[78:79]
    v_lshrrev_b32 v22, 6, v0
    v_and_b32 v1, 63, v0
    v_readfirstlane_b32 s32, v22
    v_and_b32 v3, 15, v0
    v_lshlrev_b32 v24, 4, v1
    v_lshlrev_b32 v23, 2, v3
    s_and_b32 s49, s2, 15
    s_lshl_b32 s53, s32, 12
    v_add_u32 v25, s53, v24
    s_lshl_b32 s54, s49, 10
    s_cmp_lt_u32 s2, 128
    s_cselect_b32 s55, s32, 0
    s_cmp_lg_u32 s55, 0
    s_cselect_b32 s54, s54, 0
    v_add_u32 v26, s54, v24
    s_waitcnt lgkmcnt(0)
    global_load_dword v21, v23, s[12:13]
    global_load_dwordx4 v[196:199], v26, s[10:11]
    s_cbranch_scc1 L_worker
    global_load_dwordx4 v[200:203], v25, s[10:11] offset:0
    global_load_dwordx4 v[204:207], v25, s[10:11] offset:1024
    global_load_dwordx4 v[208:211], v25, s[10:11] offset:2048
    global_load_dwordx4 v[212:215], v25, s[10:11] offset:3072
    s_cmp_ge_u32 s2, 128
    s_cbranch_scc1 L_other
    s_branch L_aux
L_worker:
    s_lshr_b32 s33, s2, 4
    s_lshl_b32 s54, s49, 13
    s_lshl_b32 s55, s33, 10
    s_add_u32 s54, s54, s55
    v_add_u32 v29, s54, v24
    s_add_u32 m0, s53, 49152
    v_lshrrev_b32 v2, 4, v1
    global_load_lds_dwordx4 v29, s[4:5]
    s_mov_b32 s20, s6
    s_mov_b32 s21, s7
    s_mov_b32 s22, 0x4400000
    s_mov_b32 s23, 0x20000
    s_mov_b32 s24, s8
    s_mov_b32 s25, s9
    s_mov_b32 s26, 0x4400000
    s_mov_b32 s27, 0x20000
    s_mov_b32 s28, s18
    s_mov_b32 s29, s19
    s_mov_b32 s30, 0x1008000
    s_mov_b32 s31, 0x20000
    s_lshl_b32 s50, s32, 13
    s_lshl_b32 s54, s33, 8
    v_lshlrev_b32 v8, 13, v2
    v_lshl_add_u32 v8, v3, 4, v8
    v_add_u32 v8, s54, v8
    v_add_u32 v9, 0x1000, v8
    v_add_u32 v27, 0, v2
    v_xor_b32 v28, v27, v3
    v_lshlrev_b32 v28, 4, v28
    v_lshl_add_u32 v10, v3, 8, v28
    v_add_u32 v10, s50, v10
    v_lshl_add_u32 v4, v27, 11, v28
    v_add_u32 v4, s54, v4
    v_add_u32 v27, 4, v2
    v_xor_b32 v28, v27, v3
    v_lshlrev_b32 v28, 4, v28
    v_lshl_add_u32 v11, v3, 8, v28
    v_add_u32 v11, s50, v11
    v_lshl_add_u32 v5, v27, 11, v28
    v_add_u32 v5, s54, v5
    v_add_u32 v27, 8, v2
    v_xor_b32 v28, v27, v3
    v_lshlrev_b32 v28, 4, v28
    v_lshl_add_u32 v12, v3, 8, v28
    v_add_u32 v12, s50, v12
    v_lshl_add_u32 v6, v27, 11, v28
    v_add_u32 v6, s54, v6
    v_add_u32 v27, 12, v2
    v_xor_b32 v28, v27, v3
    v_lshlrev_b32 v28, 4, v28
    v_lshl_add_u32 v13, v3, 8, v28
    v_add_u32 v13, s50, v13
    v_lshl_add_u32 v7, v27, 11, v28
    v_add_u32 v7, s54, v7
    s_sub_u32 s54, s32, 1
    v_mad_u32_u24 v44, v1, 3, s54
    s_waitcnt vmcnt(1)
    ds_write_b128 v25, v[196:199] offset:32768
    v_readlane_b32 s67, v21, s49
    s_min_i32 s54, s67, 0x1000
    s_cmp_le_i32 s67, 0
    s_cselect_b32 s67, 0x1000, s54
    s_cselect_b32 s52, 1, 0
    s_sub_u32 s68, s67, 1
    s_lshr_b32 s68, s68, 4
    v_sub_u32 v45, s68, v44
    v_max_i32 v26, 0, v45
    v_lshl_add_u32 v26, v26, 2, s53
    ds_read_b32 v14, v26 offset:32768
    s_waitcnt lgkmcnt(0)
    v_lshlrev_b32 v14, 15, v14
    s_nop 0
    v_readlane_b32 s43, v14, 0
    v_readlane_b32 s44, v14, 1
    s_nop 2
    s_add_u32 m0, s50, 0
    s_nop 0
    buffer_load_dwordx4 v4, s[20:23], s43 offen nt lds
    s_add_u32 m0, s50, 1024
    s_nop 0
    buffer_load_dwordx4 v5, s[20:23], s43 offen nt lds
    s_add_u32 m0, s50, 2048
    s_nop 0
    buffer_load_dwordx4 v6, s[20:23], s43 offen nt lds
    s_add_u32 m0, s50, 3072
    s_nop 0
    buffer_load_dwordx4 v7, s[20:23], s43 offen nt lds
    buffer_load_dwordx4 v[108:111], v8, s[24:27], s43 offen offset:0 nt
    buffer_load_dwordx4 v[112:115], v8, s[24:27], s43 offen offset:2048 nt
    buffer_load_dwordx4 v[116:119], v9, s[24:27], s43 offen offset:0 nt
    buffer_load_dwordx4 v[120:123], v9, s[24:27], s43 offen offset:2048 nt
    s_mov_b32 s46, 0x3e0293ee
    s_mov_b32 s60, 0x40faf233
    s_mov_b32 s47, 0x05040100
    s_mov_b32 s48, 0x07060302
    v_and_b32 v27, 3, v3
    v_lshlrev_b32 v18, 8, v27
    v_lshl_add_u32 v18, v2, 4, v18
    v_lshlrev_b32 v19, 6, v2
    v_lshl_add_u32 v19, v27, 4, v19
    v_add_u32 v19, 65536, v19
    v_lshlrev_b32 v20, 2, v2
    v_mov_b32 v30, 0x3f803f80
    v_mov_b32 v31, 0x3f803f80
    v_add_u32 v18, s53, v18
    s_lshl_b32 s53, s32, 11
    v_add_u32 v19, s53, v19
    s_waitcnt vmcnt(8)
    ds_read_b128 v[140:143], v18 offset:49152
    ds_read_b128 v[144:147], v18 offset:49216
    ds_read_b128 v[148:151], v18 offset:49280
    ds_read_b128 v[152:155], v18 offset:49344
    v_mov_b32 v156, 0
    v_mov_b32 v157, 0
    v_mov_b32 v158, 0
    v_mov_b32 v159, 0
    v_mov_b32 v160, 0
    v_mov_b32 v161, 0
    v_mov_b32 v162, 0
    v_mov_b32 v163, 0
    v_mov_b32 v164, 0
    v_mov_b32 v165, 0
    v_mov_b32 v166, 0
    v_mov_b32 v167, 0
    v_mov_b32 v168, 0
    v_mov_b32 v169, 0
    v_mov_b32 v170, 0
    v_mov_b32 v171, 0
    v_mov_b32 v172, 0
    v_mov_b32 v173, 0
    v_mov_b32 v174, 0
    v_mov_b32 v175, 0
    v_mov_b32 v176, 0
    v_mov_b32 v177, 0
    v_mov_b32 v178, 0
    v_mov_b32 v179, 0
    v_mov_b32 v180, 0
    v_mov_b32 v181, 0
    v_mov_b32 v182, 0
    v_mov_b32 v183, 0
    v_mov_b32 v184, 0
    v_mov_b32 v185, 0
    v_mov_b32 v186, 0
    v_mov_b32 v187, 0
    v_mov_b32 v40, 0
    v_mov_b32 v41, 0
    v_mov_b32 v42, 0
    v_mov_b32 v43, 0
    v_mov_b32 v32, 0xff7fffff
    v_mov_b32 v36, 0xff800000
    s_lshl_b32 s53, s32, 3
    s_add_u32 s53, s53, 104448
    v_lshl_add_u32 v47, v1, 6, s53
    s_lshl_b32 s53, s32, 4
    s_add_u32 s53, s53, 65536
    v_and_b32 v22, 3, v1
    v_lshl_add_u32 v48, v22, 9, s53
    v_lshl_add_u32 v48, v2, 6, v48
    v_and_b32 v22, 12, v1
    v_add_u32 v48, v22, v48
    s_lshl_b32 s53, s32, 6
    s_add_u32 s53, s53, 104448
    v_mov_b32 v49, s53
    s_lshl_b32 s53, s49, 13
    s_lshl_b32 s54, s33, 10
    s_add_u32 s53, s53, s54
    s_lshl_b32 s54, s32, 8
    s_add_u32 s53, s53, s54
    v_lshl_add_u32 v50, v1, 2, s53
    v_lshlrev_b32 v25, 4, v45
    v_sub_u32 v25, s67, v25
    v_min_u32 v15, 16, v25
    v_mov_b32 v23, 108544
    v_mov_b32 v22, 0x80000000
    s_mov_b32 s41, 0
    s_mov_b32 s64, 0
    s_mov_b32 s70, 0
    s_waitcnt lgkmcnt(0)
    s_cmp_eq_u32 s52, 0
    s_cbranch_scc1 L_o_go
    v_mov_b32 v140, 0
    v_mov_b32 v141, 0
    v_mov_b32 v142, 0
    v_mov_b32 v143, 0
    v_mov_b32 v144, 0
    v_mov_b32 v145, 0
    v_mov_b32 v146, 0
    v_mov_b32 v147, 0
    v_mov_b32 v148, 0
    v_mov_b32 v149, 0
    v_mov_b32 v150, 0
    v_mov_b32 v151, 0
    v_mov_b32 v152, 0
    v_mov_b32 v153, 0
    v_mov_b32 v154, 0
    v_mov_b32 v155, 0
L_o_go:
    s_barrier
    ds_read_b32 v23, v23
    s_waitcnt lgkmcnt(0)
    v_cmp_gt_u32 vcc, v23, v44
    s_nop 0
    s_bcnt1_i32_b64 s40, vcc
    v_cndmask_b32 v14, v22, v14, vcc
    s_min_u32 s40, s40, 60
    s_and_b32 s53, s33, 3
    s_cmp_eq_u32 s53, 1
    s_cselect_b32 s53, 0, 8
    s_sub_i32 s69, s40, s53
    s_max_i32 s69, s69, 0
    v_mov_b32 v37, 108548
    s_sub_i32 s51, s40, 2
    s_cmp_eq_u32 s40, 0
    s_cbranch_scc1 L_o_done
L_o_loop:
L_o_pos0:
    s_cmp_lg_u32 s41, s51
    s_cbranch_scc1 L_gt0
    ds_write_b32 v37, v30
L_gt0:
    s_add_u32 s53, s41, 2
    v_readlane_b32 s42, v15, s41
    v_readlane_b32 s45, v14, s53
    s_waitcnt vmcnt(6)
    s_add_u32 m0, s50, 4096
    s_nop 0
    buffer_load_dwordx4 v4, s[20:23], s44 offen nt lds
    s_add_u32 m0, s50, 5120
    s_nop 0
    buffer_load_dwordx4 v5, s[20:23], s44 offen nt lds
    s_waitcnt vmcnt(6)
    ds_read_b128 v[76:79], v10 offset:0
    ds_read_b128 v[80:83], v11 offset:0
    ds_read_b128 v[84:87], v12 offset:0
    ds_read_b128 v[88:91], v13 offset:0
    s_add_u32 m0, s50, 6144
    s_nop 0
    buffer_load_dwordx4 v6, s[20:23], s44 offen nt lds
    s_add_u32 m0, s50, 7168
    s_nop 0
    buffer_load_dwordx4 v7, s[20:23], s44 offen nt lds
    s_waitcnt lgkmcnt(3)
    v_mfma_f32_16x16x32_bf16 v[52:55], v[76:79], v[140:143], 0
    s_waitcnt lgkmcnt(2)
    v_mfma_f32_16x16x32_bf16 v[52:55], v[80:83], v[144:147], v[52:55]
    s_waitcnt lgkmcnt(1)
    v_mfma_f32_16x16x32_bf16 v[52:55], v[84:87], v[148:151], v[52:55]
    s_waitcnt lgkmcnt(0)
    v_mfma_f32_16x16x32_bf16 v[52:55], v[88:91], v[152:155], v[52:55]
    s_cmp_lt_u32 s42, 16
    s_nop 6
    s_cbranch_scc1 L_o_mask0
L_o_maskret0:
    v_max3_f32 v22, v52, v53, v54
    v_max_f32 v22, v22, v55
    v_cmp_gt_f32 vcc, v22, v36
    s_cbranch_vccnz L_o_resc0
L_o_rescret0:
    v_fma_f32 v52, v52, s46, -v32
    v_fma_f32 v53, v53, s46, -v32
    v_fma_f32 v54, v54, s46, -v32
    v_fma_f32 v55, v55, s46, -v32
    v_exp_f32 v52, v52
    v_exp_f32 v53, v53
    v_exp_f32 v54, v54
    v_exp_f32 v55, v55
    v_cvt_pk_bf16_f32 v68, v52, v53
    s_nop 0
    v_cvt_pk_bf16_f32 v69, v54, v55
    s_waitcnt vmcnt(6)
    buffer_load_dwordx4 v[124:127], v8, s[24:27], s44 offen offset:0 nt
    buffer_load_dwordx4 v[128:131], v8, s[24:27], s44 offen offset:2048 nt
    v_mfma_f32_16x16x16_bf16 v[40:43], v[30:31], v[68:69], v[40:43]
    v_perm_b32 v92, v112, v108, s47
    v_perm_b32 v94, v112, v108, s48
    v_perm_b32 v96, v113, v109, s47
    v_perm_b32 v98, v113, v109, s48
    v_perm_b32 v100, v114, v110, s47
    v_perm_b32 v102, v114, v110, s48
    v_perm_b32 v104, v115, v111, s47
    v_perm_b32 v106, v115, v111, s48
    s_waitcnt vmcnt(6)
    buffer_load_dwordx4 v[132:135], v9, s[24:27], s44 offen offset:0 nt
    buffer_load_dwordx4 v[136:139], v9, s[24:27], s44 offen offset:2048 nt
    v_perm_b32 v93, v120, v116, s47
    v_perm_b32 v95, v120, v116, s48
    v_perm_b32 v97, v121, v117, s47
    v_perm_b32 v99, v121, v117, s48
    v_perm_b32 v101, v122, v118, s47
    v_perm_b32 v103, v122, v118, s48
    v_perm_b32 v105, v123, v119, s47
    v_perm_b32 v107, v123, v119, s48
    s_mov_b32 s43, s44
    s_mov_b32 s44, s45
    v_mfma_f32_16x16x16_bf16 v[156:159], v[92:93], v[68:69], v[156:159]
    v_mfma_f32_16x16x16_bf16 v[160:163], v[94:95], v[68:69], v[160:163]
    v_mfma_f32_16x16x16_bf16 v[164:167], v[96:97], v[68:69], v[164:167]
    v_mfma_f32_16x16x16_bf16 v[168:171], v[98:99], v[68:69], v[168:171]
    v_mfma_f32_16x16x16_bf16 v[172:175], v[100:101], v[68:69], v[172:175]
    v_mfma_f32_16x16x16_bf16 v[176:179], v[102:103], v[68:69], v[176:179]
    v_mfma_f32_16x16x16_bf16 v[180:183], v[104:105], v[68:69], v[180:183]
    v_mfma_f32_16x16x16_bf16 v[184:187], v[106:107], v[68:69], v[184:187]
    s_add_u32 s41, s41, 1
    s_cmp_lt_u32 s41, s69
    s_cbranch_scc0 L_o_tr0
L_o_pos1:
    s_cmp_lg_u32 s41, s51
    s_cbranch_scc1 L_gt1
    ds_write_b32 v37, v30
L_gt1:
    s_add_u32 s53, s41, 2
    v_readlane_b32 s42, v15, s41
    v_readlane_b32 s45, v14, s53
    s_waitcnt vmcnt(6)
    s_add_u32 m0, s50, 0
    s_nop 0
    buffer_load_dwordx4 v4, s[20:23], s44 offen nt lds
    s_add_u32 m0, s50, 1024
    s_nop 0
    buffer_load_dwordx4 v5, s[20:23], s44 offen nt lds
    s_waitcnt vmcnt(6)
    ds_read_b128 v[76:79], v10 offset:4096
    ds_read_b128 v[80:83], v11 offset:4096
    ds_read_b128 v[84:87], v12 offset:4096
    ds_read_b128 v[88:91], v13 offset:4096
    s_add_u32 m0, s50, 2048
    s_nop 0
    buffer_load_dwordx4 v6, s[20:23], s44 offen nt lds
    s_add_u32 m0, s50, 3072
    s_nop 0
    buffer_load_dwordx4 v7, s[20:23], s44 offen nt lds
    s_waitcnt lgkmcnt(3)
    v_mfma_f32_16x16x32_bf16 v[52:55], v[76:79], v[140:143], 0
    s_waitcnt lgkmcnt(2)
    v_mfma_f32_16x16x32_bf16 v[52:55], v[80:83], v[144:147], v[52:55]
    s_waitcnt lgkmcnt(1)
    v_mfma_f32_16x16x32_bf16 v[52:55], v[84:87], v[148:151], v[52:55]
    s_waitcnt lgkmcnt(0)
    v_mfma_f32_16x16x32_bf16 v[52:55], v[88:91], v[152:155], v[52:55]
    s_cmp_lt_u32 s42, 16
    s_nop 6
    s_cbranch_scc1 L_o_mask1
L_o_maskret1:
    v_max3_f32 v22, v52, v53, v54
    v_max_f32 v22, v22, v55
    v_cmp_gt_f32 vcc, v22, v36
    s_cbranch_vccnz L_o_resc1
L_o_rescret1:
    v_fma_f32 v52, v52, s46, -v32
    v_fma_f32 v53, v53, s46, -v32
    v_fma_f32 v54, v54, s46, -v32
    v_fma_f32 v55, v55, s46, -v32
    v_exp_f32 v52, v52
    v_exp_f32 v53, v53
    v_exp_f32 v54, v54
    v_exp_f32 v55, v55
    v_cvt_pk_bf16_f32 v68, v52, v53
    s_nop 0
    v_cvt_pk_bf16_f32 v69, v54, v55
    s_waitcnt vmcnt(6)
    buffer_load_dwordx4 v[108:111], v8, s[24:27], s44 offen offset:0 nt
    buffer_load_dwordx4 v[112:115], v8, s[24:27], s44 offen offset:2048 nt
    v_mfma_f32_16x16x16_bf16 v[40:43], v[30:31], v[68:69], v[40:43]
    v_perm_b32 v92, v128, v124, s47
    v_perm_b32 v94, v128, v124, s48
    v_perm_b32 v96, v129, v125, s47
    v_perm_b32 v98, v129, v125, s48
    v_perm_b32 v100, v130, v126, s47
    v_perm_b32 v102, v130, v126, s48
    v_perm_b32 v104, v131, v127, s47
    v_perm_b32 v106, v131, v127, s48
    s_waitcnt vmcnt(6)
    buffer_load_dwordx4 v[116:119], v9, s[24:27], s44 offen offset:0 nt
    buffer_load_dwordx4 v[120:123], v9, s[24:27], s44 offen offset:2048 nt
    v_perm_b32 v93, v136, v132, s47
    v_perm_b32 v95, v136, v132, s48
    v_perm_b32 v97, v137, v133, s47
    v_perm_b32 v99, v137, v133, s48
    v_perm_b32 v101, v138, v134, s47
    v_perm_b32 v103, v138, v134, s48
    v_perm_b32 v105, v139, v135, s47
    v_perm_b32 v107, v139, v135, s48
    s_mov_b32 s43, s44
    s_mov_b32 s44, s45
    v_mfma_f32_16x16x16_bf16 v[156:159], v[92:93], v[68:69], v[156:159]
    v_mfma_f32_16x16x16_bf16 v[160:163], v[94:95], v[68:69], v[160:163]
    v_mfma_f32_16x16x16_bf16 v[164:167], v[96:97], v[68:69], v[164:167]
    v_mfma_f32_16x16x16_bf16 v[168:171], v[98:99], v[68:69], v[168:171]
    v_mfma_f32_16x16x16_bf16 v[172:175], v[100:101], v[68:69], v[172:175]
    v_mfma_f32_16x16x16_bf16 v[176:179], v[102:103], v[68:69], v[176:179]
    v_mfma_f32_16x16x16_bf16 v[180:183], v[104:105], v[68:69], v[180:183]
    v_mfma_f32_16x16x16_bf16 v[184:187], v[106:107], v[68:69], v[184:187]
    s_add_u32 s41, s41, 1
    s_cmp_lt_u32 s41, s69
    s_cbranch_scc1 L_o_loop
    s_branch L_o_tr1
L_o_tr0:
    s_cmp_ge_u32 s41, s40
    s_cbranch_scc1 L_o_done
    s_add_u32 m0, s50, 0
    s_nop 0
    buffer_load_dwordx4 v4, s[20:23], s44 offen nt lds
    s_add_u32 m0, s50, 1024
    s_nop 0
    buffer_load_dwordx4 v5, s[20:23], s44 offen nt lds
    s_add_u32 m0, s50, 2048
    s_nop 0
    buffer_load_dwordx4 v6, s[20:23], s44 offen nt lds
    s_add_u32 m0, s50, 3072
    s_nop 0
    buffer_load_dwordx4 v7, s[20:23], s44 offen nt lds
    s_branch L_oB_pos1
L_o_tr1:
    s_cmp_ge_u32 s41, s40
    s_cbranch_scc1 L_o_done
    s_add_u32 m0, s50, 4096
    s_nop 0
    buffer_load_dwordx4 v4, s[20:23], s44 offen nt lds
    s_add_u32 m0, s50, 5120
    s_nop 0
    buffer_load_dwordx4 v5, s[20:23], s44 offen nt lds
    s_add_u32 m0, s50, 6144
    s_nop 0
    buffer_load_dwordx4 v6, s[20:23], s44 offen nt lds
    s_add_u32 m0, s50, 7168
    s_nop 0
    buffer_load_dwordx4 v7, s[20:23], s44 offen nt lds
    s_branch L_oB_pos0
L_o_mask0:
    v_mov_b32 v23, 0xff800000
    v_add_u32 v22, 0, v20
    v_cmp_gt_u32 vcc, s42, v22
    s_nop 1
    v_cndmask_b32 v52, v23, v52, vcc
    v_add_u32 v22, 1, v20
    v_cmp_gt_u32 vcc, s42, v22
    s_nop 1
    v_cndmask_b32 v53, v23, v53, vcc
    v_add_u32 v22, 2, v20
    v_cmp_gt_u32 vcc, s42, v22
    s_nop 1
    v_cndmask_b32 v54, v23, v54, vcc
    v_add_u32 v22, 3, v20
    v_cmp_gt_u32 vcc, s42, v22
    s_nop 1
    v_cndmask_b32 v55, v23, v55, vcc
    s_branch L_o_maskret0
L_o_resc0:
    s_call_b64 s[72:73], L_sub_resc_p
    s_branch L_o_rescret0
L_o_mask1:
    v_mov_b32 v23, 0xff800000
    v_add_u32 v22, 0, v20
    v_cmp_gt_u32 vcc, s42, v22
    s_nop 1
    v_cndmask_b32 v52, v23, v52, vcc
    v_add_u32 v22, 1, v20
    v_cmp_gt_u32 vcc, s42, v22
    s_nop 1
    v_cndmask_b32 v53, v23, v53, vcc
    v_add_u32 v22, 2, v20
    v_cmp_gt_u32 vcc, s42, v22
    s_nop 1
    v_cndmask_b32 v54, v23, v54, vcc
    v_add_u32 v22, 3, v20
    v_cmp_gt_u32 vcc, s42, v22
    s_nop 1
    v_cndmask_b32 v55, v23, v55, vcc
    s_branch L_o_maskret1
L_o_resc1:
    s_call_b64 s[72:73], L_sub_resc_p
    s_branch L_o_rescret1
L_oB_loop:
L_oB_pos0:
    s_cmp_lg_u32 s41, s51
    s_cbranch_scc1 L_gtB0
    ds_write_b32 v37, v30
L_gtB0:
    s_add_u32 s53, s41, 2
    v_readlane_b32 s42, v15, s41
    v_readlane_b32 s45, v14, s53
    s_waitcnt vmcnt(10)
    buffer_load_dwordx4 v[124:127], v8, s[24:27], s44 offen offset:0 nt
    buffer_load_dwordx4 v[128:131], v8, s[24:27], s44 offen offset:2048 nt
    s_waitcnt vmcnt(10)
    ds_read_b128 v[76:79], v10 offset:0
    ds_read_b128 v[80:83], v11 offset:0
    ds_read_b128 v[84:87], v12 offset:0
    ds_read_b128 v[88:91], v13 offset:0
    buffer_load_dwordx4 v[132:135], v9, s[24:27], s44 offen offset:0 nt
    buffer_load_dwordx4 v[136:139], v9, s[24:27], s44 offen offset:2048 nt
    s_waitcnt lgkmcnt(3)
    v_mfma_f32_16x16x32_bf16 v[52:55], v[76:79], v[140:143], 0
    s_waitcnt lgkmcnt(2)
    v_mfma_f32_16x16x32_bf16 v[52:55], v[80:83], v[144:147], v[52:55]
    s_waitcnt lgkmcnt(1)
    v_mfma_f32_16x16x32_bf16 v[52:55], v[84:87], v[148:151], v[52:55]
    s_waitcnt lgkmcnt(0)
    v_mfma_f32_16x16x32_bf16 v[52:55], v[88:91], v[152:155], v[52:55]
    s_cmp_lt_u32 s42, 16
    s_nop 6
    s_cbranch_scc1 L_oB_mask0
L_oB_maskret0:
    v_max3_f32 v22, v52, v53, v54
    v_max_f32 v22, v22, v55
    v_cmp_gt_f32 vcc, v22, v36
    s_cbranch_vccnz L_oB_resc0
L_oB_rescret0:
    v_fma_f32 v52, v52, s46, -v32
    v_fma_f32 v53, v53, s46, -v32
    v_fma_f32 v54, v54, s46, -v32
    v_fma_f32 v55, v55, s46, -v32
    v_exp_f32 v52, v52
    v_exp_f32 v53, v53
    v_exp_f32 v54, v54
    v_exp_f32 v55, v55
    v_cvt_pk_bf16_f32 v68, v52, v53
    s_nop 0
    v_cvt_pk_bf16_f32 v69, v54, v55
    s_waitcnt vmcnt(10)
    s_add_u32 m0, s50, 0
    s_nop 0
    buffer_load_dwordx4 v4, s[20:23], s45 offen nt lds
    s_add_u32 m0, s50, 1024
    s_nop 0
    buffer_load_dwordx4 v5, s[20:23], s45 offen nt lds
    v_mfma_f32_16x16x16_bf16 v[40:43], v[30:31], v[68:69], v[40:43]
    v_perm_b32 v92, v112, v108, s47
    v_perm_b32 v94, v112, v108, s48
    v_perm_b32 v96, v113, v109, s47
    v_perm_b32 v98, v113, v109, s48
    v_perm_b32 v100, v114, v110, s47
    v_perm_b32 v102, v114, v110, s48
    v_perm_b32 v104, v115, v111, s47
    v_perm_b32 v106, v115, v111, s48
    s_waitcnt vmcnt(10)
    s_add_u32 m0, s50, 2048
    s_nop 0
    buffer_load_dwordx4 v6, s[20:23], s45 offen nt lds
    s_add_u32 m0, s50, 3072
    s_nop 0
    buffer_load_dwordx4 v7, s[20:23], s45 offen nt lds
    v_perm_b32 v93, v120, v116, s47
    v_perm_b32 v95, v120, v116, s48
    v_perm_b32 v97, v121, v117, s47
    v_perm_b32 v99, v121, v117, s48
    v_perm_b32 v101, v122, v118, s47
    v_perm_b32 v103, v122, v118, s48
    v_perm_b32 v105, v123, v119, s47
    v_perm_b32 v107, v123, v119, s48
    s_mov_b32 s43, s44
    s_mov_b32 s44, s45
    v_mfma_f32_16x16x16_bf16 v[156:159], v[92:93], v[68:69], v[156:159]
    v_mfma_f32_16x16x16_bf16 v[160:163], v[94:95], v[68:69], v[160:163]
    v_mfma_f32_16x16x16_bf16 v[164:167], v[96:97], v[68:69], v[164:167]
    v_mfma_f32_16x16x16_bf16 v[168:171], v[98:99], v[68:69], v[168:171]
    v_mfma_f32_16x16x16_bf16 v[172:175], v[100:101], v[68:69], v[172:175]
    v_mfma_f32_16x16x16_bf16 v[176:179], v[102:103], v[68:69], v[176:179]
    v_mfma_f32_16x16x16_bf16 v[180:183], v[104:105], v[68:69], v[180:183]
    v_mfma_f32_16x16x16_bf16 v[184:187], v[106:107], v[68:69], v[184:187]
    s_add_u32 s41, s41, 1
    s_cmp_lt_u32 s41, s40
    s_cbranch_scc0 L_o_done
L_oB_pos1:
    s_cmp_lg_u32 s41, s51
    s_cbranch_scc1 L_gtB1
    ds_write_b32 v37, v30
L_gtB1:
    s_add_u32 s53, s41, 2
    v_readlane_b32 s42, v15, s41
    v_readlane_b32 s45, v14, s53
    s_waitcnt vmcnt(10)
    buffer_load_dwordx4 v[108:111], v8, s[24:27], s44 offen offset:0 nt
    buffer_load_dwordx4 v[112:115], v8, s[24:27], s44 offen offset:2048 nt
    s_waitcnt vmcnt(10)
    ds_read_b128 v[76:79], v10 offset:4096
    ds_read_b128 v[80:83], v11 offset:4096
    ds_read_b128 v[84:87], v12 offset:4096
    ds_read_b128 v[88:91], v13 offset:4096
    buffer_load_dwordx4 v[116:119], v9, s[24:27], s44 offen offset:0 nt
    buffer_load_dwordx4 v[120:123], v9, s[24:27], s44 offen offset:2048 nt
    s_waitcnt lgkmcnt(3)
    v_mfma_f32_16x16x32_bf16 v[52:55], v[76:79], v[140:143], 0
    s_waitcnt lgkmcnt(2)
    v_mfma_f32_16x16x32_bf16 v[52:55], v[80:83], v[144:147], v[52:55]
    s_waitcnt lgkmcnt(1)
    v_mfma_f32_16x16x32_bf16 v[52:55], v[84:87], v[148:151], v[52:55]
    s_waitcnt lgkmcnt(0)
    v_mfma_f32_16x16x32_bf16 v[52:55], v[88:91], v[152:155], v[52:55]
    s_cmp_lt_u32 s42, 16
    s_nop 6
    s_cbranch_scc1 L_oB_mask1
L_oB_maskret1:
    v_max3_f32 v22, v52, v53, v54
    v_max_f32 v22, v22, v55
    v_cmp_gt_f32 vcc, v22, v36
    s_cbranch_vccnz L_oB_resc1
L_oB_rescret1:
    v_fma_f32 v52, v52, s46, -v32
    v_fma_f32 v53, v53, s46, -v32
    v_fma_f32 v54, v54, s46, -v32
    v_fma_f32 v55, v55, s46, -v32
    v_exp_f32 v52, v52
    v_exp_f32 v53, v53
    v_exp_f32 v54, v54
    v_exp_f32 v55, v55
    v_cvt_pk_bf16_f32 v68, v52, v53
    s_nop 0
    v_cvt_pk_bf16_f32 v69, v54, v55
    s_waitcnt vmcnt(10)
    s_add_u32 m0, s50, 4096
    s_nop 0
    buffer_load_dwordx4 v4, s[20:23], s45 offen nt lds
    s_add_u32 m0, s50, 5120
    s_nop 0
    buffer_load_dwordx4 v5, s[20:23], s45 offen nt lds
    v_mfma_f32_16x16x16_bf16 v[40:43], v[30:31], v[68:69], v[40:43]
    v_perm_b32 v92, v128, v124, s47
    v_perm_b32 v94, v128, v124, s48
    v_perm_b32 v96, v129, v125, s47
    v_perm_b32 v98, v129, v125, s48
    v_perm_b32 v100, v130, v126, s47
    v_perm_b32 v102, v130, v126, s48
    v_perm_b32 v104, v131, v127, s47
    v_perm_b32 v106, v131, v127, s48
    s_waitcnt vmcnt(10)
    s_add_u32 m0, s50, 6144
    s_nop 0
    buffer_load_dwordx4 v6, s[20:23], s45 offen nt lds
    s_add_u32 m0, s50, 7168
    s_nop 0
    buffer_load_dwordx4 v7, s[20:23], s45 offen nt lds
    v_perm_b32 v93, v136, v132, s47
    v_perm_b32 v95, v136, v132, s48
    v_perm_b32 v97, v137, v133, s47
    v_perm_b32 v99, v137, v133, s48
    v_perm_b32 v101, v138, v134, s47
    v_perm_b32 v103, v138, v134, s48
    v_perm_b32 v105, v139, v135, s47
    v_perm_b32 v107, v139, v135, s48
    s_mov_b32 s43, s44
    s_mov_b32 s44, s45
    v_mfma_f32_16x16x16_bf16 v[156:159], v[92:93], v[68:69], v[156:159]
    v_mfma_f32_16x16x16_bf16 v[160:163], v[94:95], v[68:69], v[160:163]
    v_mfma_f32_16x16x16_bf16 v[164:167], v[96:97], v[68:69], v[164:167]
    v_mfma_f32_16x16x16_bf16 v[168:171], v[98:99], v[68:69], v[168:171]
    v_mfma_f32_16x16x16_bf16 v[172:175], v[100:101], v[68:69], v[172:175]
    v_mfma_f32_16x16x16_bf16 v[176:179], v[102:103], v[68:69], v[176:179]
    v_mfma_f32_16x16x16_bf16 v[180:183], v[104:105], v[68:69], v[180:183]
    v_mfma_f32_16x16x16_bf16 v[184:187], v[106:107], v[68:69], v[184:187]
    s_add_u32 s41, s41, 1
    s_cmp_lt_u32 s41, s40
    s_cbranch_scc1 L_oB_loop
    s_branch L_o_done
L_oB_mask0:
    v_mov_b32 v23, 0xff800000
    v_add_u32 v22, 0, v20
    v_cmp_gt_u32 vcc, s42, v22
    s_nop 1
    v_cndmask_b32 v52, v23, v52, vcc
    v_add_u32 v22, 1, v20
    v_cmp_gt_u32 vcc, s42, v22
    s_nop 1
    v_cndmask_b32 v53, v23, v53, vcc
    v_add_u32 v22, 2, v20
    v_cmp_gt_u32 vcc, s42, v22
    s_nop 1
    v_cndmask_b32 v54, v23, v54, vcc
    v_add_u32 v22, 3, v20
    v_cmp_gt_u32 vcc, s42, v22
    s_nop 1
    v_cndmask_b32 v55, v23, v55, vcc
    s_branch L_oB_maskret0
L_oB_resc0:
    s_call_b64 s[72:73], L_sub_resc_p
    s_branch L_oB_rescret0
L_oB_mask1:
    v_mov_b32 v23, 0xff800000
    v_add_u32 v22, 0, v20
    v_cmp_gt_u32 vcc, s42, v22
    s_nop 1
    v_cndmask_b32 v52, v23, v52, vcc
    v_add_u32 v22, 1, v20
    v_cmp_gt_u32 vcc, s42, v22
    s_nop 1
    v_cndmask_b32 v53, v23, v53, vcc
    v_add_u32 v22, 2, v20
    v_cmp_gt_u32 vcc, s42, v22
    s_nop 1
    v_cndmask_b32 v54, v23, v54, vcc
    v_add_u32 v22, 3, v20
    v_cmp_gt_u32 vcc, s42, v22
    s_nop 1
    v_cndmask_b32 v55, v23, v55, vcc
    s_branch L_oB_maskret1
L_oB_resc1:
    s_call_b64 s[72:73], L_sub_resc_p
    s_branch L_oB_rescret1
L_aux:
    v_add_u32 v25, 0x1000, v25
    global_load_dwordx4 v[108:111], v25, s[10:11] offset:0
    global_load_dwordx4 v[112:115], v25, s[10:11] offset:1024
    global_load_dwordx4 v[116:119], v25, s[10:11] offset:2048
    global_load_dwordx4 v[120:123], v25, s[10:11] offset:3072
    v_add_u32 v25, 0x1000, v25
    global_load_dwordx4 v[124:127], v25, s[10:11] offset:0
    global_load_dwordx4 v[128:131], v25, s[10:11] offset:1024
    global_load_dwordx4 v[132:135], v25, s[10:11] offset:2048
    global_load_dwordx4 v[136:139], v25, s[10:11] offset:3072
    v_add_u32 v25, 0x1000, v25
    global_load_dwordx4 v[140:143], v25, s[10:11] offset:0
    global_load_dwordx4 v[144:147], v25, s[10:11] offset:1024
    global_load_dwordx4 v[148:151], v25, s[10:11] offset:2048
    global_load_dwordx4 v[152:155], v25, s[10:11] offset:3072
    s_lshl_b32 s54, s2, 2
    s_add_u32 s54, s54, 0x0
    v_mov_b32 v46, s54
    global_load_dword v51, v46, s[18:19]
    s_lshr_b32 s33, s2, 4
    v_lshrrev_b32 v2, 4, v1
    s_and_b32 s54, s33, 3
    s_mov_b32 s36, 0x3f943eea
    s_cmp_eq_u32 s54, 1
    s_cselect_b32 s61, 19, 15
    s_cselect_b32 s35, 30, 25
    s_cselect_b32 s36, 0x3f8f1ee2, s36
    s_mov_b32 s20, s6
    s_mov_b32 s21, s7
    s_mov_b32 s22, 0x4400000
    s_mov_b32 s23, 0x20000
    s_mov_b32 s24, s8
    s_mov_b32 s25, s9
    s_mov_b32 s26, 0x4400000
    s_mov_b32 s27, 0x20000
    s_mov_b32 s28, s18
    s_mov_b32 s29, s19
    s_mov_b32 s30, 0x1008000
    s_mov_b32 s31, 0x20000
    v_add_u32 v228, 1, v3
    s_add_u32 s55, s61, 16
    v_sub_u32 v229, s55, v228
    v_mul_u32_u24 v228, 20, v228
    v_mul_u32_u24 v229, s35, v229
    v_sub_u32 v230, s55, v3
    v_sub_u32 v231, s61, v3
    v_cvt_f32_u32 v230, v230
    v_cvt_f32_i32 v231, v231
    v_rcp_f32 v230, v230
    v_rcp_f32 v231, v231
    v_mov_b32 v232, 108544
    v_lshl_add_u32 v233, s32, 2, v232
    v_mul_f32 v230, s36, v230
    v_mul_f32 v231, 0x46800000, v231
    s_mov_b32 s41, 0
    s_mov_b32 s51, 0
    s_waitcnt vmcnt(18)
    v_cmp_gt_i32 vcc, 1, v21
    v_mov_b32 v22, 0x1000
    v_min_i32 v21, v21, v22
    s_and_b32 s52, vcc_lo, 0xffff
    v_cndmask_b32 v21, v21, v22, vcc
    v_add_u32 v17, 15, v21
    v_mov_b32 v22, v21
    v_lshrrev_b32 v17, 4, v17
    v_mov_b32 v23, v17
    s_nop 0
    v_min_u32_dpp v22, v22, v22 row_ror:8 row_mask:0xf bank_mask:0xf
    v_add_u32_dpp v23, v23, v23 row_ror:8 row_mask:0xf bank_mask:0xf
    s_nop 0
    v_min_u32_dpp v22, v22, v22 row_ror:4 row_mask:0xf bank_mask:0xf
    v_add_u32_dpp v23, v23, v23 row_ror:4 row_mask:0xf bank_mask:0xf
    s_nop 0
    v_min_u32_dpp v22, v22, v22 row_ror:2 row_mask:0xf bank_mask:0xf
    v_add_u32_dpp v23, v23, v23 row_ror:2 row_mask:0xf bank_mask:0xf
    s_nop 0
    v_min_u32_dpp v22, v22, v22 row_ror:1 row_mask:0xf bank_mask:0xf
    v_add_u32_dpp v23, v23, v23 row_ror:1 row_mask:0xf bank_mask:0xf
    v_readfirstlane_b32 s34, v22
    v_readfirstlane_b32 s66, v23
    s_lshr_b32 s34, s34, 4
    s_cmp_lg_u32 s52, 0
    s_cselect_b32 s34, 0, s34
    s_waitcnt vmcnt(13)
    v_cmp_ne_u64 s[78:79], v[196:197], v[204:205]
    v_cmp_ne_u64 s[80:81], v[198:199], v[206:207]
    v_cmp_ne_u64 s[82:83], v[196:197], v[208:209]
    v_cmp_ne_u64 s[84:85], v[198:199], v[210:211]
    s_or_b64 s[78:79], s[78:79], s[82:83]
    s_or_b64 s[80:81], s[80:81], s[84:85]
    v_cmp_ne_u64 s[82:83], v[196:197], v[212:213]
    v_cmp_ne_u64 s[84:85], v[198:199], v[214:215]
    s_or_b64 s[78:79], s[78:79], s[82:83]
    s_or_b64 s[80:81], s[80:81], s[84:85]
    s_waitcnt vmcnt(10)
    v_cmp_ne_u64 s[82:83], v[196:197], v[108:109]
    v_cmp_ne_u64 s[84:85], v[198:199], v[110:111]
    s_or_b64 s[78:79], s[78:79], s[82:83]
    s_or_b64 s[80:81], s[80:81], s[84:85]
    v_cmp_ne_u64 s[82:83], v[196:197], v[112:113]
    v_cmp_ne_u64 s[84:85], v[198:199], v[114:115]
    s_or_b64 s[78:79], s[78:79], s[82:83]
    s_or_b64 s[80:81], s[80:81], s[84:85]
    v_cmp_ne_u64 s[82:83], v[196:197], v[116:117]
    v_cmp_ne_u64 s[84:85], v[198:199], v[118:119]
    s_or_b64 s[78:79], s[78:79], s[82:83]
    s_or_b64 s[80:81], s[80:81], s[84:85]
    s_waitcnt vmcnt(7)
    v_cmp_ne_u64 s[82:83], v[196:197], v[120:121]
    v_cmp_ne_u64 s[84:85], v[198:199], v[122:123]
    s_or_b64 s[78:79], s[78:79], s[82:83]
    s_or_b64 s[80:81], s[80:81], s[84:85]
    v_cmp_ne_u64 s[82:83], v[196:197], v[124:125]
    v_cmp_ne_u64 s[84:85], v[198:199], v[126:127]
    s_or_b64 s[78:79], s[78:79], s[82:83]
    s_or_b64 s[80:81], s[80:81], s[84:85]
    v_cmp_ne_u64 s[82:83], v[196:197], v[128:129]
    v_cmp_ne_u64 s[84:85], v[198:199], v[130:131]
    s_or_b64 s[78:79], s[78:79], s[82:83]
    s_or_b64 s[80:81], s[80:81], s[84:85]
    s_waitcnt vmcnt(4)
    v_cmp_ne_u64 s[82:83], v[196:197], v[132:133]
    v_cmp_ne_u64 s[84:85], v[198:199], v[134:135]
    s_or_b64 s[78:79], s[78:79], s[82:83]
    s_or_b64 s[80:81], s[80:81], s[84:85]
    v_cmp_ne_u64 s[82:83], v[196:197], v[136:137]
    v_cmp_ne_u64 s[84:85], v[198:199], v[138:139]
    s_or_b64 s[78:79], s[78:79], s[82:83]
    s_or_b64 s[80:81], s[80:81], s[84:85]
    v_cmp_ne_u64 s[82:83], v[196:197], v[140:141]
    v_cmp_ne_u64 s[84:85], v[198:199], v[142:143]
    s_or_b64 s[78:79], s[78:79], s[82:83]
    s_or_b64 s[80:81], s[80:81], s[84:85]
    s_waitcnt vmcnt(1)
    v_cmp_ne_u64 s[82:83], v[196:197], v[144:145]
    v_cmp_ne_u64 s[84:85], v[198:199], v[146:147]
    s_or_b64 s[78:79], s[78:79], s[82:83]
    s_or_b64 s[80:81], s[80:81], s[84:85]
    v_cmp_ne_u64 s[82:83], v[196:197], v[148:149]
    v_cmp_ne_u64 s[84:85], v[198:199], v[150:151]
    s_or_b64 s[78:79], s[78:79], s[82:83]
    s_or_b64 s[80:81], s[80:81], s[84:85]
    v_cmp_ne_u64 s[82:83], v[196:197], v[152:153]
    v_cmp_ne_u64 s[84:85], v[198:199], v[154:155]
    s_or_b64 s[78:79], s[78:79], s[82:83]
    s_or_b64 s[80:81], s[80:81], s[84:85]
    s_or_b64 s[78:79], s[78:79], s[80:81]
    s_ff1_i32_b64 s53, s[78:79]
    s_min_u32 s53, s53, 64
    s_lshl_b32 s53, s53, 2
    s_min_u32 s34, s34, s53
    v_mov_b32 v196, s34
    v_lshlrev_b32 v197, 4, v196
    v_sub_u32 v197, s66, v197
    v_mul_u32_u24 v229, v196, v229
    v_mul_u32_u24 v228, v197, v228
    v_cvt_f32_u32 v198, v197
    v_cmp_le_u32 vcc, v229, v228
    v_readfirstlane_b32 s34, v196
    v_mul_f32 v198, v198, v230
    v_sub_u32 v29, v17, v196
    s_ff1_i32_b32 s35, vcc_lo
    v_cvt_u32_f32 v198, v198
    s_min_u32 s35, s35, 9
    s_add_u32 s35, s35, 1
    s_cmp_eq_u32 s34, 0
    s_cselect_b32 s35, 0, s35
    v_readlane_b32 s36, v198, s35
    v_readlane_b32 s38, v231, s35
    s_max_u32 s36, s36, 1
    v_readlane_b32 s54, v29, s49
    s_min_u32 s54, s54, s36
    s_nop 0
    v_mov_b32 v22, s54
    v_mov_b32 v23, 0
    ds_write_b64 v232, v[22:23]
    s_waitcnt lgkmcnt(0)
    s_barrier
    s_waitcnt vmcnt(0)
    v_readfirstlane_b32 s70, v51
    s_mul_i32 s70, s70, 0x9e3779b1
    s_add_u32 s70, s70, 0x7f4a7c15
    v_mov_b32 v51, s70
    v_subrev_u32 v17, s36, v29
    v_max_i32 v17, 0, v17
    s_sub_u32 s39, s61, s35
    s_lshl_b32 s39, s39, 2
    v_add_u32_dpp v199, v17, v17 row_shr:1 row_mask:0xf bank_mask:0xf bound_ctrl:0
    v_add_u32_dpp v199, v17, v199 row_shr:2 row_mask:0xf bank_mask:0xf bound_ctrl:0
    v_add_u32_dpp v199, v17, v199 row_shr:3 row_mask:0xf bank_mask:0xf bound_ctrl:0
    s_nop 1
    v_add_u32_dpp v16, v199, v199 row_shr:4 row_mask:0xf bank_mask:0xf bound_ctrl:0
    v_add_u32_dpp v16, v199, v16 row_shr:8 row_mask:0xf bank_mask:0xf bound_ctrl:0
    v_add_u32_dpp v16, v199, v16 row_shr:12 row_mask:0xf bank_mask:0xf bound_ctrl:0
    v_cvt_f32_u32 v198, v16
    v_readlane_b32 s37, v16, 15
    v_mul_f32 v198, s38, v198
    v_cvt_u32_f32 v198, v198
    s_nop 0
    v_readlane_b32 s38, v198, 15
    s_lshl_b32 s53, s32, 3
    s_add_u32 s53, s53, 104448
    v_lshl_add_u32 v47, v1, 6, s53
    s_lshl_b32 s53, s32, 4
    s_add_u32 s53, s53, 65536
    v_and_b32 v22, 3, v1
    v_lshl_add_u32 v48, v22, 9, s53
    v_lshl_add_u32 v48, v2, 6, v48
    v_and_b32 v22, 12, v1
    v_add_u32 v48, v22, v48
    s_lshl_b32 s53, s32, 6
    s_add_u32 s53, s53, 104448
    v_mov_b32 v49, s53
    s_lshl_b32 s53, s49, 13
    s_lshl_b32 s54, s33, 10
    s_add_u32 s53, s53, s54
    s_lshl_b32 s54, s32, 8
    s_add_u32 s53, s53, s54
    v_lshl_add_u32 v50, v1, 2, s53
    v_mov_b32 v37, 108548
    s_call_b64 s[72:73], L_sub_mask
    s_mov_b32 s62, 4096
    s_mov_b32 s52, s57
    s_mov_b32 s36, 0
    s_mov_b32 s61, 1
    s_mul_i32 s59, s2, 3072
    s_add_u32 s59, s59, 0x8000
    v_lshlrev_b32 v76, 9, v2
    v_lshl_add_u32 v76, v3, 4, v76
    v_and_b32 v77, 3, v1
    v_lshlrev_b32 v77, 3, v77
    v_lshlrev_b32 v90, 4, v1
    v_mul_u32_u24 v28, 0x60000, v1
    v_mov_b32 v29, 0
    s_waitcnt vmcnt(0) lgkmcnt(0)
    v_mov_b32 v62, 0xff7fffff
    v_mov_b32 v64, 0
    v_mov_b32 v52, 0
    v_mov_b32 v53, 0
    v_mov_b32 v54, 0
    v_mov_b32 v56, 0
    v_mov_b32 v57, 0
    v_mov_b32 v58, 0
    v_mov_b32 v60, 0
    v_mov_b32 v61, 0
    s_mov_b32 s64, 0
L_poll:
    s_cmp_eq_u32 s52, 0
    s_cbranch_scc1 L_o_gdone
    s_cmp_eq_u32 s62, 0
    s_cbranch_scc1 L_owner_slow
    s_sub_u32 s62, s62, 1
    s_and_b32 s57, s36, s52
    s_bcnt1_i32_b32 s53, s52
    s_cmp_le_u32 s53, 2
    s_cbranch_scc1 L_poll_spec
    ds_read_b32 v22, v37
    s_waitcnt lgkmcnt(0)
    v_readfirstlane_b32 s54, v22
    s_cmp_le_u32 s53, 6
    s_cselect_b32 s54, s54, 0
    s_cmp_lg_u32 s54, 0
    s_cbranch_scc1 L_poll_spec
    s_mov_b32 exec_lo, s52
    s_mov_b32 exec_hi, 0
    buffer_load_dword v29, v28, s[28:31], s59 offen offset:3068 sc1
    s_mov_b64 exec, -1
    s_cmp_lg_u32 s57, 0
    s_cbranch_scc1 L_poll_g
    s_waitcnt vmcnt(0)
    s_branch L_poll_n
L_poll_spec:
    s_mov_b32 s57, s52
L_poll_g:
    s_call_b64 s[72:73], L_sub_round
    s_andn2_b32 s52, s52, s66
L_poll_n:
    v_cmp_eq_u32 vcc, s70, v29
    s_nop 0
    s_mov_b32 s36, vcc_lo
    s_branch L_poll
L_o_gdone:
L_o_putG:
    v_add_u32 v78, 65536, v76
    v_mov_b32 v55, v58
    v_mov_b32 v63, v64
    ds_write_b64 v78, v[52:53]
    ds_write_b64 v78, v[56:57] offset:8
    ds_write_b64 v78, v[60:61] offset:256
    ds_write_b64 v78, v[54:55] offset:264
    s_mov_b64 exec, 15
    ds_write_b64 v47, v[62:63]
    s_mov_b64 exec, -1
    s_cmp_eq_u32 s52, 0
    s_cbranch_scc0 L_o_bar
    s_mov_b64 exec, 1
    global_store_dword v46, v51, s[18:19] sc1
    s_mov_b64 exec, -1
    s_branch L_o_bar
L_o_done:
    s_nop 1
    v_mov_b32 v33, v40
    s_mov_b32 exec_lo, 0x000f000f
    s_mov_b32 exec_hi, 0x000f000f
    ds_write_b128 v19, v[156:159] offset:0
    ds_write_b128 v19, v[160:163] offset:256
    ds_write_b128 v19, v[164:167] offset:512
    ds_write_b128 v19, v[168:171] offset:768
    ds_write_b128 v19, v[172:175] offset:1024
    ds_write_b128 v19, v[176:179] offset:1280
    ds_write_b128 v19, v[180:183] offset:1536
    ds_write_b128 v19, v[184:187] offset:1792
    s_mov_b64 exec, 15
    ds_write_b64 v47, v[32:33]
    ds_write_b32 v37, v30
    s_mov_b64 exec, -1
L_o_bar:
    s_cmp_lg_u32 s64, 0
    s_waitcnt lgkmcnt(0)
    s_cbranch_scc1 L_o_nb
    s_barrier
L_o_nb:
    ds_read_b128 v[92:95], v49
    ds_read_b128 v[96:99], v49 offset:16
    ds_read2st64_b32 v[140:141], v48 offset0:0 offset1:1
    ds_read2st64_b32 v[142:143], v48 offset0:8 offset1:9
    ds_read2st64_b32 v[144:145], v48 offset0:16 offset1:17
    ds_read2st64_b32 v[146:147], v48 offset0:24 offset1:25
    s_waitcnt lgkmcnt(4)
    v_max3_f32 v22, v92, v94, v96
    v_cmp_gt_f32 vcc, 0, v93
    v_max_f32 v22, v22, v98
    v_sub_f32 v92, v92, v22
    v_sub_f32 v94, v94, v22
    v_sub_f32 v96, v96, v22
    v_sub_f32 v98, v98, v22
    s_cbranch_vccnz L_o_slow2
    v_exp_f32 v92, v92
    v_exp_f32 v94, v94
    v_exp_f32 v96, v96
    v_exp_f32 v98, v98
    v_mul_f32 v23, v92, v93
    v_fmac_f32 v23, v94, v95
    v_fmac_f32 v23, v96, v97
    v_fmac_f32 v23, v98, v99
    v_rcp_f32 v24, v23
    s_waitcnt lgkmcnt(0)
    v_pk_mul_f32 v[140:141], v[140:141], v[92:93] op_sel_hi:[1,0]
    v_pk_fma_f32 v[140:141], v[142:143], v[94:95], v[140:141] op_sel_hi:[1,0,1]
    v_pk_fma_f32 v[140:141], v[144:145], v[96:97], v[140:141] op_sel_hi:[1,0,1]
    v_pk_fma_f32 v[140:141], v[146:147], v[98:99], v[140:141] op_sel_hi:[1,0,1]
    v_pk_mul_f32 v[140:141], v[140:141], v[24:25] op_sel_hi:[1,0]
    v_cvt_pk_bf16_f32 v22, v140, v141
    global_store_dword v50, v22, s[14:15]
    s_endpgm
L_owner_slow:
    v_lshlrev_b32 v76, 9, v2
    v_lshl_add_u32 v76, v3, 4, v76
    v_and_b32 v77, 3, v1
    v_lshlrev_b32 v77, 3, v77
    v_lshlrev_b32 v90, 4, v1
    s_waitcnt lgkmcnt(0)
    v_mov_b32 v62, 0xff7fffff
    v_mov_b32 v64, 0
    v_mov_b32 v52, 0
    v_mov_b32 v53, 0
    v_mov_b32 v54, 0
    v_mov_b32 v56, 0
    v_mov_b32 v57, 0
    v_mov_b32 v58, 0
    v_mov_b32 v60, 0
    v_mov_b32 v61, 0
    v_mov_b32 v64, -1.0
    s_branch L_o_putG
L_o_slow2:
    s_cmp_lg_u32 s32, 0
    s_cbranch_scc1 L_fin
    s_waitcnt lgkmcnt(0)
    v_lshlrev_b32 v76, 9, v2
    v_lshl_add_u32 v76, v3, 4, v76
    v_and_b32 v77, 3, v1
    v_lshlrev_b32 v77, 3, v77
    v_lshlrev_b32 v90, 4, v1
    v_mov_b32 v62, 0xff7fffff
    v_mov_b32 v64, 0
    v_mov_b32 v52, 0
    v_mov_b32 v53, 0
    v_mov_b32 v54, 0
    v_mov_b32 v56, 0
    v_mov_b32 v57, 0
    v_mov_b32 v58, 0
    v_mov_b32 v60, 0
    v_mov_b32 v61, 0
    s_mov_b32 s69, 0
    s_call_b64 s[72:73], L_sub_mask
    s_call_b64 s[72:73], L_sub_mergelds
    s_mov_b32 s62, 31
    s_mov_b32 s64, 0x100
    s_call_b64 s[72:73], L_sub_publish
    s_cmp_eq_u32 s65, s58
    s_cbranch_scc0 L_fin
    s_call_b64 s[76:77], L_sub_gather
    s_call_b64 s[72:73], L_sub_out
    s_branch L_fin
L_sub_resc_p:
    v_mov_b32 v26, v22
    s_nop 1
    v_permlane32_swap_b32 v22, v26
    s_nop 0
    v_max_f32 v22, v22, v26
    v_mov_b32 v26, v22
    s_nop 1
    v_permlane16_swap_b32 v22, v26
    s_nop 0
    v_max_f32 v22, v22, v26
    v_mul_f32 v22, s46, v22
    v_max_f32 v22, v22, v32
    v_sub_f32 v26, v32, v22
    v_exp_f32 v26, v26
    v_mov_b32 v32, v22
    v_add_f32 v27, 0x41000000, v22
    v_mul_f32 v36, s60, v27
    v_pk_mul_f32 v[40:41], v[40:41], v[26:27] op_sel_hi:[1,0]
    v_pk_mul_f32 v[42:43], v[42:43], v[26:27] op_sel_hi:[1,0]
    v_pk_mul_f32 v[156:157], v[156:157], v[26:27] op_sel_hi:[1,0]
    v_pk_mul_f32 v[158:159], v[158:159], v[26:27] op_sel_hi:[1,0]
    v_pk_mul_f32 v[160:161], v[160:161], v[26:27] op_sel_hi:[1,0]
    v_pk_mul_f32 v[162:163], v[162:163], v[26:27] op_sel_hi:[1,0]
    v_pk_mul_f32 v[164:165], v[164:165], v[26:27] op_sel_hi:[1,0]
    v_pk_mul_f32 v[166:167], v[166:167], v[26:27] op_sel_hi:[1,0]
    v_pk_mul_f32 v[168:169], v[168:169], v[26:27] op_sel_hi:[1,0]
    v_pk_mul_f32 v[170:171], v[170:171], v[26:27] op_sel_hi:[1,0]
    v_pk_mul_f32 v[172:173], v[172:173], v[26:27] op_sel_hi:[1,0]
    v_pk_mul_f32 v[174:175], v[174:175], v[26:27] op_sel_hi:[1,0]
    v_pk_mul_f32 v[176:177], v[176:177], v[26:27] op_sel_hi:[1,0]
    v_pk_mul_f32 v[178:179], v[178:179], v[26:27] op_sel_hi:[1,0]
    v_pk_mul_f32 v[180:181], v[180:181], v[26:27] op_sel_hi:[1,0]
    v_pk_mul_f32 v[182:183], v[182:183], v[26:27] op_sel_hi:[1,0]
    v_pk_mul_f32 v[184:185], v[184:185], v[26:27] op_sel_hi:[1,0]
    v_pk_mul_f32 v[186:187], v[186:187], v[26:27] op_sel_hi:[1,0]
    s_setpc_b64 s[72:73]
L_sub_round:
    s_mov_b32 s66, 0
    s_ff1_i32_b32 s53, s57
    s_mul_i32 s54, s53, 0x60000
    s_add_u32 s54, s54, s59
    s_lshl_b32 s43, 1, s53
    s_and_b32 s43, s43, s57
    s_andn2_b32 s57, s57, s43
    buffer_load_dwordx4 v[156:159], v90, s[28:31], s54 offen offset:0 sc1
    buffer_load_dwordx4 v[160:163], v90, s[28:31], s54 offen offset:1024 sc1
    buffer_load_dwordx4 v[164:167], v90, s[28:31], s54 offen offset:2048 sc1
    s_ff1_i32_b32 s53, s57
    s_mul_i32 s54, s53, 0x60000
    s_add_u32 s54, s54, s59
    s_lshl_b32 s44, 1, s53
    s_and_b32 s44, s44, s57
    s_cbranch_scc0 L_rd_w1
    s_andn2_b32 s57, s57, s44
    buffer_load_dwordx4 v[168:171], v90, s[28:31], s54 offen offset:0 sc1
    buffer_load_dwordx4 v[172:175], v90, s[28:31], s54 offen offset:1024 sc1
    buffer_load_dwordx4 v[176:179], v90, s[28:31], s54 offen offset:2048 sc1
    s_ff1_i32_b32 s53, s57
    s_mul_i32 s54, s53, 0x60000
    s_add_u32 s54, s54, s59
    s_lshl_b32 s45, 1, s53
    s_and_b32 s45, s45, s57
    s_cbranch_scc0 L_rd_w2
    s_andn2_b32 s57, s57, s45
    buffer_load_dwordx4 v[180:183], v90, s[28:31], s54 offen offset:0 sc1
    buffer_load_dwordx4 v[184:187], v90, s[28:31], s54 offen offset:1024 sc1
    buffer_load_dwordx4 v[188:191], v90, s[28:31], s54 offen offset:2048 sc1
    s_ff1_i32_b32 s53, s57
    s_mul_i32 s54, s53, 0x60000
    s_add_u32 s54, s54, s59
    s_lshl_b32 s42, 1, s53
    s_and_b32 s42, s42, s57
    s_cbranch_scc0 L_rd_w3
    s_andn2_b32 s57, s57, s42
    buffer_load_dwordx4 v[192:195], v90, s[28:31], s54 offen offset:0 sc1
    buffer_load_dwordx4 v[196:199], v90, s[28:31], s54 offen offset:1024 sc1
    buffer_load_dwordx4 v[200:203], v90, s[28:31], s54 offen offset:2048 sc1
    s_ff1_i32_b32 s53, s57
    s_mul_i32 s54, s53, 0x60000
    s_add_u32 s54, s54, s59
    s_lshl_b32 s67, 1, s53
    s_and_b32 s67, s67, s57
    s_cbranch_scc0 L_rd_w4
    s_andn2_b32 s57, s57, s67
    buffer_load_dwordx4 v[204:207], v90, s[28:31], s54 offen offset:0 sc1
    buffer_load_dwordx4 v[208:211], v90, s[28:31], s54 offen offset:1024 sc1
    buffer_load_dwordx4 v[212:215], v90, s[28:31], s54 offen offset:2048 sc1
    s_ff1_i32_b32 s53, s57
    s_mul_i32 s54, s53, 0x60000
    s_add_u32 s54, s54, s59
    s_lshl_b32 s68, 1, s53
    s_and_b32 s68, s68, s57
    s_cbranch_scc0 L_rd_w5
    s_andn2_b32 s57, s57, s68
    buffer_load_dwordx4 v[216:219], v90, s[28:31], s54 offen offset:0 sc1
    buffer_load_dwordx4 v[220:223], v90, s[28:31], s54 offen offset:1024 sc1
    buffer_load_dwordx4 v[224:227], v90, s[28:31], s54 offen offset:2048 sc1
    s_waitcnt vmcnt(0)
    v_xor_b32 v159, s70, v159
    v_xor_b32 v163, s70, v163
    v_xor_b32 v167, s70, v167
    v_or3_b32 v159, v159, v163, v167
    v_mul_lo_u32 v159, v159, s61
    v_cmp_ne_u32 vcc, 0, v159
    s_or_b32 s66, s66, s43
    s_cbranch_vccz L_rd_ok6_0
    s_andn2_b32 s66, s66, s43
    v_mov_b32 v156, 0
    v_mov_b32 v157, 0
    v_mov_b32 v158, 0
    v_mov_b32 v160, 0
    v_mov_b32 v161, 0
    v_mov_b32 v162, 0
    v_mov_b32 v164, 0
    v_mov_b32 v165, 0
    v_mov_b32 v166, 0xff7fffff
L_rd_ok6_0:
    v_xor_b32 v171, s70, v171
    v_xor_b32 v175, s70, v175
    v_xor_b32 v179, s70, v179
    v_or3_b32 v171, v171, v175, v179
    v_mul_lo_u32 v171, v171, s61
    v_cmp_ne_u32 vcc, 0, v171
    s_or_b32 s66, s66, s44
    s_cbranch_vccz L_rd_ok6_1
    s_andn2_b32 s66, s66, s44
    v_mov_b32 v168, 0
    v_mov_b32 v169, 0
    v_mov_b32 v170, 0
    v_mov_b32 v172, 0
    v_mov_b32 v173, 0
    v_mov_b32 v174, 0
    v_mov_b32 v176, 0
    v_mov_b32 v177, 0
    v_mov_b32 v178, 0xff7fffff
L_rd_ok6_1:
    v_xor_b32 v183, s70, v183
    v_xor_b32 v187, s70, v187
    v_xor_b32 v191, s70, v191
    v_or3_b32 v183, v183, v187, v191
    v_mul_lo_u32 v183, v183, s61
    v_cmp_ne_u32 vcc, 0, v183
    s_or_b32 s66, s66, s45
    s_cbranch_vccz L_rd_ok6_2
    s_andn2_b32 s66, s66, s45
    v_mov_b32 v180, 0
    v_mov_b32 v181, 0
    v_mov_b32 v182, 0
    v_mov_b32 v184, 0
    v_mov_b32 v185, 0
    v_mov_b32 v186, 0
    v_mov_b32 v188, 0
    v_mov_b32 v189, 0
    v_mov_b32 v190, 0xff7fffff
L_rd_ok6_2:
    v_xor_b32 v195, s70, v195
    v_xor_b32 v199, s70, v199
    v_xor_b32 v203, s70, v203
    v_or3_b32 v195, v195, v199, v203
    v_mul_lo_u32 v195, v195, s61
    v_cmp_ne_u32 vcc, 0, v195
    s_or_b32 s66, s66, s42
    s_cbranch_vccz L_rd_ok6_3
    s_andn2_b32 s66, s66, s42
    v_mov_b32 v192, 0
    v_mov_b32 v193, 0
    v_mov_b32 v194, 0
    v_mov_b32 v196, 0
    v_mov_b32 v197, 0
    v_mov_b32 v198, 0
    v_mov_b32 v200, 0
    v_mov_b32 v201, 0
    v_mov_b32 v202, 0xff7fffff
L_rd_ok6_3:
    v_xor_b32 v207, s70, v207
    v_xor_b32 v211, s70, v211
    v_xor_b32 v215, s70, v215
    v_or3_b32 v207, v207, v211, v215
    v_mul_lo_u32 v207, v207, s61
    v_cmp_ne_u32 vcc, 0, v207
    s_or_b32 s66, s66, s67
    s_cbranch_vccz L_rd_ok6_4
    s_andn2_b32 s66, s66, s67
    v_mov_b32 v204, 0
    v_mov_b32 v205, 0
    v_mov_b32 v206, 0
    v_mov_b32 v208, 0
    v_mov_b32 v209, 0
    v_mov_b32 v210, 0
    v_mov_b32 v212, 0
    v_mov_b32 v213, 0
    v_mov_b32 v214, 0xff7fffff
L_rd_ok6_4:
    v_xor_b32 v219, s70, v219
    v_xor_b32 v223, s70, v223
    v_xor_b32 v227, s70, v227
    v_or3_b32 v219, v219, v223, v227
    v_mul_lo_u32 v219, v219, s61
    v_cmp_ne_u32 vcc, 0, v219
    s_or_b32 s66, s66, s68
    s_cbranch_vccz L_rd_ok6_5
    s_andn2_b32 s66, s66, s68
    v_mov_b32 v216, 0
    v_mov_b32 v217, 0
    v_mov_b32 v218, 0
    v_mov_b32 v220, 0
    v_mov_b32 v221, 0
    v_mov_b32 v222, 0
    v_mov_b32 v224, 0
    v_mov_b32 v225, 0
    v_mov_b32 v226, 0xff7fffff
L_rd_ok6_5:
    s_cmp_eq_u32 s66, 0
    s_cbranch_scc1 L_rd_ret
    v_max3_f32 v78, v62, v166, v178
    v_max3_f32 v78, v78, v190, v202
    v_max3_f32 v78, v78, v214, v226
    v_sub_f32 v88, v62, v78
    v_sub_f32 v80, v166, v78
    v_sub_f32 v81, v178, v78
    v_sub_f32 v82, v190, v78
    v_sub_f32 v83, v202, v78
    v_sub_f32 v84, v214, v78
    v_sub_f32 v85, v226, v78
    v_exp_f32 v88, v88
    v_exp_f32 v80, v80
    v_exp_f32 v81, v81
    v_exp_f32 v82, v82
    v_exp_f32 v83, v83
    v_exp_f32 v84, v84
    v_exp_f32 v85, v85
    v_mov_b32 v62, v78
    v_mul_f32 v64, v64, v88
    v_pk_mul_f32 v[52:53], v[52:53], v[88:89] op_sel_hi:[1,0]
    v_pk_mul_f32 v[56:57], v[56:57], v[88:89] op_sel_hi:[1,0]
    v_pk_mul_f32 v[60:61], v[60:61], v[88:89] op_sel_hi:[1,0]
    v_mul_f32 v54, v54, v88
    v_mul_f32 v58, v58, v88
    v_add_f32 v64, v64, v80
    v_pk_fma_f32 v[52:53], v[156:157], v[80:81], v[52:53] op_sel:[0,0,0] op_sel_hi:[1,0,1]
    v_pk_fma_f32 v[56:57], v[160:161], v[80:81], v[56:57] op_sel:[0,0,0] op_sel_hi:[1,0,1]
    v_pk_fma_f32 v[60:61], v[164:165], v[80:81], v[60:61] op_sel:[0,0,0] op_sel_hi:[1,0,1]
    v_fmac_f32 v54, v158, v80
    v_fmac_f32 v58, v162, v80
    v_add_f32 v64, v64, v81
    v_pk_fma_f32 v[52:53], v[168:169], v[80:81], v[52:53] op_sel:[0,1,0] op_sel_hi:[1,1,1]
    v_pk_fma_f32 v[56:57], v[172:173], v[80:81], v[56:57] op_sel:[0,1,0] op_sel_hi:[1,1,1]
    v_pk_fma_f32 v[60:61], v[176:177], v[80:81], v[60:61] op_sel:[0,1,0] op_sel_hi:[1,1,1]
    v_fmac_f32 v54, v170, v81
    v_fmac_f32 v58, v174, v81
    v_add_f32 v64, v64, v82
    v_pk_fma_f32 v[52:53], v[180:181], v[82:83], v[52:53] op_sel:[0,0,0] op_sel_hi:[1,0,1]
    v_pk_fma_f32 v[56:57], v[184:185], v[82:83], v[56:57] op_sel:[0,0,0] op_sel_hi:[1,0,1]
    v_pk_fma_f32 v[60:61], v[188:189], v[82:83], v[60:61] op_sel:[0,0,0] op_sel_hi:[1,0,1]
    v_fmac_f32 v54, v182, v82
    v_fmac_f32 v58, v186, v82
    v_add_f32 v64, v64, v83
    v_pk_fma_f32 v[52:53], v[192:193], v[82:83], v[52:53] op_sel:[0,1,0] op_sel_hi:[1,1,1]
    v_pk_fma_f32 v[56:57], v[196:197], v[82:83], v[56:57] op_sel:[0,1,0] op_sel_hi:[1,1,1]
    v_pk_fma_f32 v[60:61], v[200:201], v[82:83], v[60:61] op_sel:[0,1,0] op_sel_hi:[1,1,1]
    v_fmac_f32 v54, v194, v83
    v_fmac_f32 v58, v198, v83
    v_add_f32 v64, v64, v84
    v_pk_fma_f32 v[52:53], v[204:205], v[84:85], v[52:53] op_sel:[0,0,0] op_sel_hi:[1,0,1]
    v_pk_fma_f32 v[56:57], v[208:209], v[84:85], v[56:57] op_sel:[0,0,0] op_sel_hi:[1,0,1]
    v_pk_fma_f32 v[60:61], v[212:213], v[84:85], v[60:61] op_sel:[0,0,0] op_sel_hi:[1,0,1]
    v_fmac_f32 v54, v206, v84
    v_fmac_f32 v58, v210, v84
    v_add_f32 v64, v64, v85
    v_pk_fma_f32 v[52:53], v[216:217], v[84:85], v[52:53] op_sel:[0,1,0] op_sel_hi:[1,1,1]
    v_pk_fma_f32 v[56:57], v[220:221], v[84:85], v[56:57] op_sel:[0,1,0] op_sel_hi:[1,1,1]
    v_pk_fma_f32 v[60:61], v[224:225], v[84:85], v[60:61] op_sel:[0,1,0] op_sel_hi:[1,1,1]
    v_fmac_f32 v54, v218, v85
    v_fmac_f32 v58, v222, v85
    s_setpc_b64 s[72:73]
L_rd_w1:
    s_waitcnt vmcnt(0)
    v_xor_b32 v159, s70, v159
    v_xor_b32 v163, s70, v163
    v_xor_b32 v167, s70, v167
    v_or3_b32 v159, v159, v163, v167
    v_mul_lo_u32 v159, v159, s61
    v_cmp_ne_u32 vcc, 0, v159
    s_or_b32 s66, s66, s43
    s_cbranch_vccz L_rd_ok1_0
    s_andn2_b32 s66, s66, s43
    v_mov_b32 v156, 0
    v_mov_b32 v157, 0
    v_mov_b32 v158, 0
    v_mov_b32 v160, 0
    v_mov_b32 v161, 0
    v_mov_b32 v162, 0
    v_mov_b32 v164, 0
    v_mov_b32 v165, 0
    v_mov_b32 v166, 0xff7fffff
L_rd_ok1_0:
    s_cmp_eq_u32 s66, 0
    s_cbranch_scc1 L_rd_ret
    v_max_f32 v78, v62, v166
    v_sub_f32 v88, v62, v78
    v_sub_f32 v80, v166, v78
    v_exp_f32 v88, v88
    v_exp_f32 v80, v80
    v_mov_b32 v62, v78
    v_mul_f32 v64, v64, v88
    v_pk_mul_f32 v[52:53], v[52:53], v[88:89] op_sel_hi:[1,0]
    v_pk_mul_f32 v[56:57], v[56:57], v[88:89] op_sel_hi:[1,0]
    v_pk_mul_f32 v[60:61], v[60:61], v[88:89] op_sel_hi:[1,0]
    v_mul_f32 v54, v54, v88
    v_mul_f32 v58, v58, v88
    v_add_f32 v64, v64, v80
    v_pk_fma_f32 v[52:53], v[156:157], v[80:81], v[52:53] op_sel:[0,0,0] op_sel_hi:[1,0,1]
    v_pk_fma_f32 v[56:57], v[160:161], v[80:81], v[56:57] op_sel:[0,0,0] op_sel_hi:[1,0,1]
    v_pk_fma_f32 v[60:61], v[164:165], v[80:81], v[60:61] op_sel:[0,0,0] op_sel_hi:[1,0,1]
    v_fmac_f32 v54, v158, v80
    v_fmac_f32 v58, v162, v80
    s_setpc_b64 s[72:73]
L_rd_w2:
    s_waitcnt vmcnt(0)
    v_xor_b32 v159, s70, v159
    v_xor_b32 v163, s70, v163
    v_xor_b32 v167, s70, v167
    v_or3_b32 v159, v159, v163, v167
    v_mul_lo_u32 v159, v159, s61
    v_cmp_ne_u32 vcc, 0, v159
    s_or_b32 s66, s66, s43
    s_cbranch_vccz L_rd_ok2_0
    s_andn2_b32 s66, s66, s43
    v_mov_b32 v156, 0
    v_mov_b32 v157, 0
    v_mov_b32 v158, 0
    v_mov_b32 v160, 0
    v_mov_b32 v161, 0
    v_mov_b32 v162, 0
    v_mov_b32 v164, 0
    v_mov_b32 v165, 0
    v_mov_b32 v166, 0xff7fffff
L_rd_ok2_0:
    v_xor_b32 v171, s70, v171
    v_xor_b32 v175, s70, v175
    v_xor_b32 v179, s70, v179
    v_or3_b32 v171, v171, v175, v179
    v_mul_lo_u32 v171, v171, s61
    v_cmp_ne_u32 vcc, 0, v171
    s_or_b32 s66, s66, s44
    s_cbranch_vccz L_rd_ok2_1
    s_andn2_b32 s66, s66, s44
    v_mov_b32 v168, 0
    v_mov_b32 v169, 0
    v_mov_b32 v170, 0
    v_mov_b32 v172, 0
    v_mov_b32 v173, 0
    v_mov_b32 v174, 0
    v_mov_b32 v176, 0
    v_mov_b32 v177, 0
    v_mov_b32 v178, 0xff7fffff
L_rd_ok2_1:
    s_cmp_eq_u32 s66, 0
    s_cbranch_scc1 L_rd_ret
    v_max3_f32 v78, v62, v166, v178
    v_sub_f32 v88, v62, v78
    v_sub_f32 v80, v166, v78
    v_sub_f32 v81, v178, v78
    v_exp_f32 v88, v88
    v_exp_f32 v80, v80
    v_exp_f32 v81, v81
    v_mov_b32 v62, v78
    v_mul_f32 v64, v64, v88
    v_pk_mul_f32 v[52:53], v[52:53], v[88:89] op_sel_hi:[1,0]
    v_pk_mul_f32 v[56:57], v[56:57], v[88:89] op_sel_hi:[1,0]
    v_pk_mul_f32 v[60:61], v[60:61], v[88:89] op_sel_hi:[1,0]
    v_mul_f32 v54, v54, v88
    v_mul_f32 v58, v58, v88
    v_add_f32 v64, v64, v80
    v_pk_fma_f32 v[52:53], v[156:157], v[80:81], v[52:53] op_sel:[0,0,0] op_sel_hi:[1,0,1]
    v_pk_fma_f32 v[56:57], v[160:161], v[80:81], v[56:57] op_sel:[0,0,0] op_sel_hi:[1,0,1]
    v_pk_fma_f32 v[60:61], v[164:165], v[80:81], v[60:61] op_sel:[0,0,0] op_sel_hi:[1,0,1]
    v_fmac_f32 v54, v158, v80
    v_fmac_f32 v58, v162, v80
    v_add_f32 v64, v64, v81
    v_pk_fma_f32 v[52:53], v[168:169], v[80:81], v[52:53] op_sel:[0,1,0] op_sel_hi:[1,1,1]
    v_pk_fma_f32 v[56:57], v[172:173], v[80:81], v[56:57] op_sel:[0,1,0] op_sel_hi:[1,1,1]
    v_pk_fma_f32 v[60:61], v[176:177], v[80:81], v[60:61] op_sel:[0,1,0] op_sel_hi:[1,1,1]
    v_fmac_f32 v54, v170, v81
    v_fmac_f32 v58, v174, v81
    s_setpc_b64 s[72:73]
L_rd_w3:
    s_waitcnt vmcnt(0)
    v_xor_b32 v159, s70, v159
    v_xor_b32 v163, s70, v163
    v_xor_b32 v167, s70, v167
    v_or3_b32 v159, v159, v163, v167
    v_mul_lo_u32 v159, v159, s61
    v_cmp_ne_u32 vcc, 0, v159
    s_or_b32 s66, s66, s43
    s_cbranch_vccz L_rd_ok3_0
    s_andn2_b32 s66, s66, s43
    v_mov_b32 v156, 0
    v_mov_b32 v157, 0
    v_mov_b32 v158, 0
    v_mov_b32 v160, 0
    v_mov_b32 v161, 0
    v_mov_b32 v162, 0
    v_mov_b32 v164, 0
    v_mov_b32 v165, 0
    v_mov_b32 v166, 0xff7fffff
L_rd_ok3_0:
    v_xor_b32 v171, s70, v171
    v_xor_b32 v175, s70, v175
    v_xor_b32 v179, s70, v179
    v_or3_b32 v171, v171, v175, v179
    v_mul_lo_u32 v171, v171, s61
    v_cmp_ne_u32 vcc, 0, v171
    s_or_b32 s66, s66, s44
    s_cbranch_vccz L_rd_ok3_1
    s_andn2_b32 s66, s66, s44
    v_mov_b32 v168, 0
    v_mov_b32 v169, 0
    v_mov_b32 v170, 0
    v_mov_b32 v172, 0
    v_mov_b32 v173, 0
    v_mov_b32 v174, 0
    v_mov_b32 v176, 0
    v_mov_b32 v177, 0
    v_mov_b32 v178, 0xff7fffff
L_rd_ok3_1:
    v_xor_b32 v183, s70, v183
    v_xor_b32 v187, s70, v187
    v_xor_b32 v191, s70, v191
    v_or3_b32 v183, v183, v187, v191
    v_mul_lo_u32 v183, v183, s61
    v_cmp_ne_u32 vcc, 0, v183
    s_or_b32 s66, s66, s45
    s_cbranch_vccz L_rd_ok3_2
    s_andn2_b32 s66, s66, s45
    v_mov_b32 v180, 0
    v_mov_b32 v181, 0
    v_mov_b32 v182, 0
    v_mov_b32 v184, 0
    v_mov_b32 v185, 0
    v_mov_b32 v186, 0
    v_mov_b32 v188, 0
    v_mov_b32 v189, 0
    v_mov_b32 v190, 0xff7fffff
L_rd_ok3_2:
    s_cmp_eq_u32 s66, 0
    s_cbranch_scc1 L_rd_ret
    v_max3_f32 v78, v62, v166, v178
    v_max_f32 v78, v78, v190
    v_sub_f32 v88, v62, v78
    v_sub_f32 v80, v166, v78
    v_sub_f32 v81, v178, v78
    v_sub_f32 v82, v190, v78
    v_exp_f32 v88, v88
    v_exp_f32 v80, v80
    v_exp_f32 v81, v81
    v_exp_f32 v82, v82
    v_mov_b32 v62, v78
    v_mul_f32 v64, v64, v88
    v_pk_mul_f32 v[52:53], v[52:53], v[88:89] op_sel_hi:[1,0]
    v_pk_mul_f32 v[56:57], v[56:57], v[88:89] op_sel_hi:[1,0]
    v_pk_mul_f32 v[60:61], v[60:61], v[88:89] op_sel_hi:[1,0]
    v_mul_f32 v54, v54, v88
    v_mul_f32 v58, v58, v88
    v_add_f32 v64, v64, v80
    v_pk_fma_f32 v[52:53], v[156:157], v[80:81], v[52:53] op_sel:[0,0,0] op_sel_hi:[1,0,1]
    v_pk_fma_f32 v[56:57], v[160:161], v[80:81], v[56:57] op_sel:[0,0,0] op_sel_hi:[1,0,1]
    v_pk_fma_f32 v[60:61], v[164:165], v[80:81], v[60:61] op_sel:[0,0,0] op_sel_hi:[1,0,1]
    v_fmac_f32 v54, v158, v80
    v_fmac_f32 v58, v162, v80
    v_add_f32 v64, v64, v81
    v_pk_fma_f32 v[52:53], v[168:169], v[80:81], v[52:53] op_sel:[0,1,0] op_sel_hi:[1,1,1]
    v_pk_fma_f32 v[56:57], v[172:173], v[80:81], v[56:57] op_sel:[0,1,0] op_sel_hi:[1,1,1]
    v_pk_fma_f32 v[60:61], v[176:177], v[80:81], v[60:61] op_sel:[0,1,0] op_sel_hi:[1,1,1]
    v_fmac_f32 v54, v170, v81
    v_fmac_f32 v58, v174, v81
    v_add_f32 v64, v64, v82
    v_pk_fma_f32 v[52:53], v[180:181], v[82:83], v[52:53] op_sel:[0,0,0] op_sel_hi:[1,0,1]
    v_pk_fma_f32 v[56:57], v[184:185], v[82:83], v[56:57] op_sel:[0,0,0] op_sel_hi:[1,0,1]
    v_pk_fma_f32 v[60:61], v[188:189], v[82:83], v[60:61] op_sel:[0,0,0] op_sel_hi:[1,0,1]
    v_fmac_f32 v54, v182, v82
    v_fmac_f32 v58, v186, v82
    s_setpc_b64 s[72:73]
L_rd_w4:
    s_waitcnt vmcnt(0)
    v_xor_b32 v159, s70, v159
    v_xor_b32 v163, s70, v163
    v_xor_b32 v167, s70, v167
    v_or3_b32 v159, v159, v163, v167
    v_mul_lo_u32 v159, v159, s61
    v_cmp_ne_u32 vcc, 0, v159
    s_or_b32 s66, s66, s43
    s_cbranch_vccz L_rd_ok4_0
    s_andn2_b32 s66, s66, s43
    v_mov_b32 v156, 0
    v_mov_b32 v157, 0
    v_mov_b32 v158, 0
    v_mov_b32 v160, 0
    v_mov_b32 v161, 0
    v_mov_b32 v162, 0
    v_mov_b32 v164, 0
    v_mov_b32 v165, 0
    v_mov_b32 v166, 0xff7fffff
L_rd_ok4_0:
    v_xor_b32 v171, s70, v171
    v_xor_b32 v175, s70, v175
    v_xor_b32 v179, s70, v179
    v_or3_b32 v171, v171, v175, v179
    v_mul_lo_u32 v171, v171, s61
    v_cmp_ne_u32 vcc, 0, v171
    s_or_b32 s66, s66, s44
    s_cbranch_vccz L_rd_ok4_1
    s_andn2_b32 s66, s66, s44
    v_mov_b32 v168, 0
    v_mov_b32 v169, 0
    v_mov_b32 v170, 0
    v_mov_b32 v172, 0
    v_mov_b32 v173, 0
    v_mov_b32 v174, 0
    v_mov_b32 v176, 0
    v_mov_b32 v177, 0
    v_mov_b32 v178, 0xff7fffff
L_rd_ok4_1:
    v_xor_b32 v183, s70, v183
    v_xor_b32 v187, s70, v187
    v_xor_b32 v191, s70, v191
    v_or3_b32 v183, v183, v187, v191
    v_mul_lo_u32 v183, v183, s61
    v_cmp_ne_u32 vcc, 0, v183
    s_or_b32 s66, s66, s45
    s_cbranch_vccz L_rd_ok4_2
    s_andn2_b32 s66, s66, s45
    v_mov_b32 v180, 0
    v_mov_b32 v181, 0
    v_mov_b32 v182, 0
    v_mov_b32 v184, 0
    v_mov_b32 v185, 0
    v_mov_b32 v186, 0
    v_mov_b32 v188, 0
    v_mov_b32 v189, 0
    v_mov_b32 v190, 0xff7fffff
L_rd_ok4_2:
    v_xor_b32 v195, s70, v195
    v_xor_b32 v199, s70, v199
    v_xor_b32 v203, s70, v203
    v_or3_b32 v195, v195, v199, v203
    v_mul_lo_u32 v195, v195, s61
    v_cmp_ne_u32 vcc, 0, v195
    s_or_b32 s66, s66, s42
    s_cbranch_vccz L_rd_ok4_3
    s_andn2_b32 s66, s66, s42
    v_mov_b32 v192, 0
    v_mov_b32 v193, 0
    v_mov_b32 v194, 0
    v_mov_b32 v196, 0
    v_mov_b32 v197, 0
    v_mov_b32 v198, 0
    v_mov_b32 v200, 0
    v_mov_b32 v201, 0
    v_mov_b32 v202, 0xff7fffff
L_rd_ok4_3:
    s_cmp_eq_u32 s66, 0
    s_cbranch_scc1 L_rd_ret
    v_max3_f32 v78, v62, v166, v178
    v_max3_f32 v78, v78, v190, v202
    v_sub_f32 v88, v62, v78
    v_sub_f32 v80, v166, v78
    v_sub_f32 v81, v178, v78
    v_sub_f32 v82, v190, v78
    v_sub_f32 v83, v202, v78
    v_exp_f32 v88, v88
    v_exp_f32 v80, v80
    v_exp_f32 v81, v81
    v_exp_f32 v82, v82
    v_exp_f32 v83, v83
    v_mov_b32 v62, v78
    v_mul_f32 v64, v64, v88
    v_pk_mul_f32 v[52:53], v[52:53], v[88:89] op_sel_hi:[1,0]
    v_pk_mul_f32 v[56:57], v[56:57], v[88:89] op_sel_hi:[1,0]
    v_pk_mul_f32 v[60:61], v[60:61], v[88:89] op_sel_hi:[1,0]
    v_mul_f32 v54, v54, v88
    v_mul_f32 v58, v58, v88
    v_add_f32 v64, v64, v80
    v_pk_fma_f32 v[52:53], v[156:157], v[80:81], v[52:53] op_sel:[0,0,0] op_sel_hi:[1,0,1]
    v_pk_fma_f32 v[56:57], v[160:161], v[80:81], v[56:57] op_sel:[0,0,0] op_sel_hi:[1,0,1]
    v_pk_fma_f32 v[60:61], v[164:165], v[80:81], v[60:61] op_sel:[0,0,0] op_sel_hi:[1,0,1]
    v_fmac_f32 v54, v158, v80
    v_fmac_f32 v58, v162, v80
    v_add_f32 v64, v64, v81
    v_pk_fma_f32 v[52:53], v[168:169], v[80:81], v[52:53] op_sel:[0,1,0] op_sel_hi:[1,1,1]
    v_pk_fma_f32 v[56:57], v[172:173], v[80:81], v[56:57] op_sel:[0,1,0] op_sel_hi:[1,1,1]
    v_pk_fma_f32 v[60:61], v[176:177], v[80:81], v[60:61] op_sel:[0,1,0] op_sel_hi:[1,1,1]
    v_fmac_f32 v54, v170, v81
    v_fmac_f32 v58, v174, v81
    v_add_f32 v64, v64, v82
    v_pk_fma_f32 v[52:53], v[180:181], v[82:83], v[52:53] op_sel:[0,0,0] op_sel_hi:[1,0,1]
    v_pk_fma_f32 v[56:57], v[184:185], v[82:83], v[56:57] op_sel:[0,0,0] op_sel_hi:[1,0,1]
    v_pk_fma_f32 v[60:61], v[188:189], v[82:83], v[60:61] op_sel:[0,0,0] op_sel_hi:[1,0,1]
    v_fmac_f32 v54, v182, v82
    v_fmac_f32 v58, v186, v82
    v_add_f32 v64, v64, v83
    v_pk_fma_f32 v[52:53], v[192:193], v[82:83], v[52:53] op_sel:[0,1,0] op_sel_hi:[1,1,1]
    v_pk_fma_f32 v[56:57], v[196:197], v[82:83], v[56:57] op_sel:[0,1,0] op_sel_hi:[1,1,1]
    v_pk_fma_f32 v[60:61], v[200:201], v[82:83], v[60:61] op_sel:[0,1,0] op_sel_hi:[1,1,1]
    v_fmac_f32 v54, v194, v83
    v_fmac_f32 v58, v198, v83
    s_setpc_b64 s[72:73]
L_rd_w5:
    s_waitcnt vmcnt(0)
    v_xor_b32 v159, s70, v159
    v_xor_b32 v163, s70, v163
    v_xor_b32 v167, s70, v167
    v_or3_b32 v159, v159, v163, v167
    v_mul_lo_u32 v159, v159, s61
    v_cmp_ne_u32 vcc, 0, v159
    s_or_b32 s66, s66, s43
    s_cbranch_vccz L_rd_ok5_0
    s_andn2_b32 s66, s66, s43
    v_mov_b32 v156, 0
    v_mov_b32 v157, 0
    v_mov_b32 v158, 0
    v_mov_b32 v160, 0
    v_mov_b32 v161, 0
    v_mov_b32 v162, 0
    v_mov_b32 v164, 0
    v_mov_b32 v165, 0
    v_mov_b32 v166, 0xff7fffff
L_rd_ok5_0:
    v_xor_b32 v171, s70, v171
    v_xor_b32 v175, s70, v175
    v_xor_b32 v179, s70, v179
    v_or3_b32 v171, v171, v175, v179
    v_mul_lo_u32 v171, v171, s61
    v_cmp_ne_u32 vcc, 0, v171
    s_or_b32 s66, s66, s44
    s_cbranch_vccz L_rd_ok5_1
    s_andn2_b32 s66, s66, s44
    v_mov_b32 v168, 0
    v_mov_b32 v169, 0
    v_mov_b32 v170, 0
    v_mov_b32 v172, 0
    v_mov_b32 v173, 0
    v_mov_b32 v174, 0
    v_mov_b32 v176, 0
    v_mov_b32 v177, 0
    v_mov_b32 v178, 0xff7fffff
L_rd_ok5_1:
    v_xor_b32 v183, s70, v183
    v_xor_b32 v187, s70, v187
    v_xor_b32 v191, s70, v191
    v_or3_b32 v183, v183, v187, v191
    v_mul_lo_u32 v183, v183, s61
    v_cmp_ne_u32 vcc, 0, v183
    s_or_b32 s66, s66, s45
    s_cbranch_vccz L_rd_ok5_2
    s_andn2_b32 s66, s66, s45
    v_mov_b32 v180, 0
    v_mov_b32 v181, 0
    v_mov_b32 v182, 0
    v_mov_b32 v184, 0
    v_mov_b32 v185, 0
    v_mov_b32 v186, 0
    v_mov_b32 v188, 0
    v_mov_b32 v189, 0
    v_mov_b32 v190, 0xff7fffff
L_rd_ok5_2:
    v_xor_b32 v195, s70, v195
    v_xor_b32 v199, s70, v199
    v_xor_b32 v203, s70, v203
    v_or3_b32 v195, v195, v199, v203
    v_mul_lo_u32 v195, v195, s61
    v_cmp_ne_u32 vcc, 0, v195
    s_or_b32 s66, s66, s42
    s_cbranch_vccz L_rd_ok5_3
    s_andn2_b32 s66, s66, s42
    v_mov_b32 v192, 0
    v_mov_b32 v193, 0
    v_mov_b32 v194, 0
    v_mov_b32 v196, 0
    v_mov_b32 v197, 0
    v_mov_b32 v198, 0
    v_mov_b32 v200, 0
    v_mov_b32 v201, 0
    v_mov_b32 v202, 0xff7fffff
L_rd_ok5_3:
    v_xor_b32 v207, s70, v207
    v_xor_b32 v211, s70, v211
    v_xor_b32 v215, s70, v215
    v_or3_b32 v207, v207, v211, v215
    v_mul_lo_u32 v207, v207, s61
    v_cmp_ne_u32 vcc, 0, v207
    s_or_b32 s66, s66, s67
    s_cbranch_vccz L_rd_ok5_4
    s_andn2_b32 s66, s66, s67
    v_mov_b32 v204, 0
    v_mov_b32 v205, 0
    v_mov_b32 v206, 0
    v_mov_b32 v208, 0
    v_mov_b32 v209, 0
    v_mov_b32 v210, 0
    v_mov_b32 v212, 0
    v_mov_b32 v213, 0
    v_mov_b32 v214, 0xff7fffff
L_rd_ok5_4:
    s_cmp_eq_u32 s66, 0
    s_cbranch_scc1 L_rd_ret
    v_max3_f32 v78, v62, v166, v178
    v_max3_f32 v78, v78, v190, v202
    v_max_f32 v78, v78, v214
    v_sub_f32 v88, v62, v78
    v_sub_f32 v80, v166, v78
    v_sub_f32 v81, v178, v78
    v_sub_f32 v82, v190, v78
    v_sub_f32 v83, v202, v78
    v_sub_f32 v84, v214, v78
    v_exp_f32 v88, v88
    v_exp_f32 v80, v80
    v_exp_f32 v81, v81
    v_exp_f32 v82, v82
    v_exp_f32 v83, v83
    v_exp_f32 v84, v84
    v_mov_b32 v62, v78
    v_mul_f32 v64, v64, v88
    v_pk_mul_f32 v[52:53], v[52:53], v[88:89] op_sel_hi:[1,0]
    v_pk_mul_f32 v[56:57], v[56:57], v[88:89] op_sel_hi:[1,0]
    v_pk_mul_f32 v[60:61], v[60:61], v[88:89] op_sel_hi:[1,0]
    v_mul_f32 v54, v54, v88
    v_mul_f32 v58, v58, v88
    v_add_f32 v64, v64, v80
    v_pk_fma_f32 v[52:53], v[156:157], v[80:81], v[52:53] op_sel:[0,0,0] op_sel_hi:[1,0,1]
    v_pk_fma_f32 v[56:57], v[160:161], v[80:81], v[56:57] op_sel:[0,0,0] op_sel_hi:[1,0,1]
    v_pk_fma_f32 v[60:61], v[164:165], v[80:81], v[60:61] op_sel:[0,0,0] op_sel_hi:[1,0,1]
    v_fmac_f32 v54, v158, v80
    v_fmac_f32 v58, v162, v80
    v_add_f32 v64, v64, v81
    v_pk_fma_f32 v[52:53], v[168:169], v[80:81], v[52:53] op_sel:[0,1,0] op_sel_hi:[1,1,1]
    v_pk_fma_f32 v[56:57], v[172:173], v[80:81], v[56:57] op_sel:[0,1,0] op_sel_hi:[1,1,1]
    v_pk_fma_f32 v[60:61], v[176:177], v[80:81], v[60:61] op_sel:[0,1,0] op_sel_hi:[1,1,1]
    v_fmac_f32 v54, v170, v81
    v_fmac_f32 v58, v174, v81
    v_add_f32 v64, v64, v82
    v_pk_fma_f32 v[52:53], v[180:181], v[82:83], v[52:53] op_sel:[0,0,0] op_sel_hi:[1,0,1]
    v_pk_fma_f32 v[56:57], v[184:185], v[82:83], v[56:57] op_sel:[0,0,0] op_sel_hi:[1,0,1]
    v_pk_fma_f32 v[60:61], v[188:189], v[82:83], v[60:61] op_sel:[0,0,0] op_sel_hi:[1,0,1]
    v_fmac_f32 v54, v182, v82
    v_fmac_f32 v58, v186, v82
    v_add_f32 v64, v64, v83
    v_pk_fma_f32 v[52:53], v[192:193], v[82:83], v[52:53] op_sel:[0,1,0] op_sel_hi:[1,1,1]
    v_pk_fma_f32 v[56:57], v[196:197], v[82:83], v[56:57] op_sel:[0,1,0] op_sel_hi:[1,1,1]
    v_pk_fma_f32 v[60:61], v[200:201], v[82:83], v[60:61] op_sel:[0,1,0] op_sel_hi:[1,1,1]
    v_fmac_f32 v54, v194, v83
    v_fmac_f32 v58, v198, v83
    v_add_f32 v64, v64, v84
    v_pk_fma_f32 v[52:53], v[204:205], v[84:85], v[52:53] op_sel:[0,0,0] op_sel_hi:[1,0,1]
    v_pk_fma_f32 v[56:57], v[208:209], v[84:85], v[56:57] op_sel:[0,0,0] op_sel_hi:[1,0,1]
    v_pk_fma_f32 v[60:61], v[212:213], v[84:85], v[60:61] op_sel:[0,0,0] op_sel_hi:[1,0,1]
    v_fmac_f32 v54, v206, v84
    v_fmac_f32 v58, v210, v84
    s_setpc_b64 s[72:73]
L_rd_ret:
    s_setpc_b64 s[72:73]
L_sub_gather:
    s_lshl_b32 s59, s33, 4
    s_add_u32 s59, s59, s49
    s_mul_i32 s59, s59, 3072
    s_add_u32 s59, s59, 0x8000
    s_mov_b32 s61, 0
L_gather_loop:
    s_cmp_eq_u32 s57, 0
    s_cbranch_scc1 L_gather_ret
    s_call_b64 s[72:73], L_sub_round
    s_branch L_gather_loop
L_gather_ret:
    s_setpc_b64 s[76:77]
L_sub_mask:
    v_readlane_b32 s53, v16, s49
    v_readlane_b32 s54, v17, s49
    s_lshl_b32 s55, s38, 2
    v_and_b32 v24, 31, v1
    v_mul_lo_u32 v22, v24, s55
    s_sub_u32 s56, s53, s54
    v_add_u32 v23, s55, v22
    v_lshrrev_b32 v22, 16, v22
    v_lshrrev_b32 v23, 16, v23
    v_min_u32 v22, s37, v22
    v_min_u32 v23, s37, v23
    s_lshr_b32 s55, s39, 2
    s_sub_u32 s55, s55, 1
    v_mov_b32 v25, s37
    v_cmp_eq_u32 vcc, s55, v1
    s_nop 1
    v_cndmask_b32 v23, v23, v25, vcc
    v_max_u32 v22, s56, v22
    v_min_u32 v23, s53, v23
    v_cmp_lt_u32 vcc, v22, v23
    v_cmp_ge_u32 s[78:79], s55, v1
    s_nop 1
    s_and_b64 vcc, vcc, s[78:79]
    s_ff1_i32_b32 s53, vcc_lo
    s_lshr_b32 s57, vcc_lo, s53
    s_lshl_b32 s57, s57, s35
    s_bfm_b32 s53, s35, 0
    s_or_b32 s57, s57, s53
    s_bcnt1_i32_b32 s58, s57
    s_setpc_b64 s[72:73]
L_other:
    s_and_b32 s55, s2, 63
    s_cmp_ge_u32 s55, 15
    s_cselect_b32 s33, 1, 0
    s_cselect_b32 s54, 15, 0
    s_cmp_ge_u32 s55, 34
    s_cselect_b32 s33, 2, s33
    s_cselect_b32 s54, 34, s54
    s_cmp_ge_u32 s55, 49
    s_cselect_b32 s33, 3, s33
    s_cselect_b32 s54, 49, s54
    s_sub_u32 s63, s55, s54
    s_bfe_u32 s55, s2, 0x10006
    s_lshl_b32 s55, s55, 2
    s_add_u32 s33, s33, s55
    v_lshrrev_b32 v2, 4, v1
    s_and_b32 s54, s33, 3
    s_mov_b32 s36, 0x3f943eea
    s_cmp_eq_u32 s54, 1
    s_cselect_b32 s61, 19, 15
    s_cselect_b32 s35, 30, 25
    s_cselect_b32 s36, 0x3f8f1ee2, s36
    s_lshl_b32 s54, s33, 2
    s_lshr_b32 s54, 0x62151540, s54
    s_and_b32 s54, s54, 15
    s_sub_u32 s63, s63, s54
    s_cselect_b32 s54, s61, 0
    s_add_u32 s63, s63, s54
    s_lshl_b32 s54, s32, 15
    s_lshl_b32 s55, s33, 10
    s_add_u32 s54, s54, s55
    v_add_u32 v51, s54, v24
    s_add_u32 s58, s53, 49152
    s_mov_b32 s20, s6
    s_mov_b32 s21, s7
    s_mov_b32 s22, 0x4400000
    s_mov_b32 s23, 0x20000
    s_mov_b32 s24, s8
    s_mov_b32 s25, s9
    s_mov_b32 s26, 0x4400000
    s_mov_b32 s27, 0x20000
    s_mov_b32 s28, s18
    s_mov_b32 s29, s19
    s_mov_b32 s30, 0x1008000
    s_mov_b32 s31, 0x20000
    s_lshl_b32 s50, s32, 13
    s_lshl_b32 s54, s33, 8
    v_lshlrev_b32 v8, 13, v2
    v_lshl_add_u32 v8, v3, 4, v8
    v_add_u32 v8, s54, v8
    v_add_u32 v9, 0x1000, v8
    v_add_u32 v27, 0, v2
    v_xor_b32 v28, v27, v3
    v_lshlrev_b32 v28, 4, v28
    v_lshl_add_u32 v10, v3, 8, v28
    v_add_u32 v10, s50, v10
    v_lshl_add_u32 v4, v27, 11, v28
    v_add_u32 v4, s54, v4
    v_add_u32 v27, 4, v2
    v_xor_b32 v28, v27, v3
    v_lshlrev_b32 v28, 4, v28
    v_lshl_add_u32 v11, v3, 8, v28
    v_add_u32 v11, s50, v11
    v_lshl_add_u32 v5, v27, 11, v28
    v_add_u32 v5, s54, v5
    v_add_u32 v27, 8, v2
    v_xor_b32 v28, v27, v3
    v_lshlrev_b32 v28, 4, v28
    v_lshl_add_u32 v12, v3, 8, v28
    v_add_u32 v12, s50, v12
    v_lshl_add_u32 v6, v27, 11, v28
    v_add_u32 v6, s54, v6
    v_add_u32 v27, 12, v2
    v_xor_b32 v28, v27, v3
    v_lshlrev_b32 v28, 4, v28
    v_lshl_add_u32 v13, v3, 8, v28
    v_add_u32 v13, s50, v13
    v_lshl_add_u32 v7, v27, 11, v28
    v_add_u32 v7, s54, v7
    v_add_u32 v228, 1, v3
    s_add_u32 s55, s61, 16
    v_sub_u32 v229, s55, v228
    v_mul_u32_u24 v228, 20, v228
    v_mul_u32_u24 v229, s35, v229
    v_sub_u32 v230, s55, v3
    v_sub_u32 v231, s61, v3
    v_cvt_f32_u32 v230, v230
    v_cvt_f32_i32 v231, v231
    v_rcp_f32 v230, v230
    v_rcp_f32 v231, v231
    v_mov_b32 v232, 108544
    v_lshl_add_u32 v233, s32, 2, v232
    v_mul_f32 v230, s36, v230
    v_mul_f32 v231, 0x46800000, v231
    s_mov_b32 s41, 0
    s_mov_b32 s51, 0
    v_mov_b32 v44, 0xff7fffff
    v_mov_b32 v45, 0
    v_mov_b32 v46, 0xff7fffff
    v_mov_b32 v47, 0
    v_lshlrev_b32 v27, 4, v0
    v_add_u32 v27, 104448, v27
    ds_write_b128 v27, v[44:47]
    s_waitcnt vmcnt(5)
    v_cmp_gt_i32 vcc, 1, v21
    v_mov_b32 v22, 0x1000
    v_min_i32 v21, v21, v22
    s_and_b32 s52, vcc_lo, 0xffff
    v_cndmask_b32 v21, v21, v22, vcc
    v_add_u32 v17, 15, v21
    v_mov_b32 v22, v21
    v_lshrrev_b32 v17, 4, v17
    v_mov_b32 v23, v17
    s_nop 0
    v_min_u32_dpp v22, v22, v22 row_ror:8 row_mask:0xf bank_mask:0xf
    v_add_u32_dpp v23, v23, v23 row_ror:8 row_mask:0xf bank_mask:0xf
    s_nop 0
    v_min_u32_dpp v22, v22, v22 row_ror:4 row_mask:0xf bank_mask:0xf
    v_add_u32_dpp v23, v23, v23 row_ror:4 row_mask:0xf bank_mask:0xf
    s_nop 0
    v_min_u32_dpp v22, v22, v22 row_ror:2 row_mask:0xf bank_mask:0xf
    v_add_u32_dpp v23, v23, v23 row_ror:2 row_mask:0xf bank_mask:0xf
    s_nop 0
    v_min_u32_dpp v22, v22, v22 row_ror:1 row_mask:0xf bank_mask:0xf
    v_add_u32_dpp v23, v23, v23 row_ror:1 row_mask:0xf bank_mask:0xf
    v_readfirstlane_b32 s34, v22
    v_readfirstlane_b32 s66, v23
    s_lshr_b32 s34, s34, 4
    s_cmp_lg_u32 s52, 0
    s_cselect_b32 s34, 0, s34
    s_waitcnt vmcnt(0)
    v_cmp_ne_u64 s[78:79], v[196:197], v[200:201]
    v_cmp_ne_u64 s[80:81], v[198:199], v[202:203]
    ds_write_b128 v25, v[200:203] offset:32768
    v_cmp_ne_u64 s[82:83], v[196:197], v[204:205]
    v_cmp_ne_u64 s[84:85], v[198:199], v[206:207]
    ds_write_b128 v25, v[204:207] offset:33792
    s_or_b64 s[78:79], s[78:79], s[82:83]
    s_or_b64 s[80:81], s[80:81], s[84:85]
    v_cmp_ne_u64 s[82:83], v[196:197], v[208:209]
    v_cmp_ne_u64 s[84:85], v[198:199], v[210:211]
    ds_write_b128 v25, v[208:211] offset:34816
    s_or_b64 s[78:79], s[78:79], s[82:83]
    s_or_b64 s[80:81], s[80:81], s[84:85]
    v_cmp_ne_u64 s[82:83], v[196:197], v[212:213]
    v_cmp_ne_u64 s[84:85], v[198:199], v[214:215]
    ds_write_b128 v25, v[212:215] offset:35840
    s_or_b64 s[78:79], s[78:79], s[82:83]
    s_or_b64 s[80:81], s[80:81], s[84:85]
    s_or_b64 s[78:79], s[78:79], s[80:81]
    s_ff1_i32_b64 s53, s[78:79]
    s_min_u32 s53, s53, 64
    s_lshl_b32 s53, s53, 2
    v_mov_b32 v28, s53
    ds_write_b32 v233, v28
    s_add_u32 m0, s58, 0
    s_nop 0
    global_load_lds_dwordx4 v51, s[4:5]
    s_add_u32 m0, s58, 1024
    v_add_u32 v51, 0x2000, v51
    global_load_lds_dwordx4 v51, s[4:5]
    s_add_u32 m0, s58, 2048
    v_add_u32 v51, 0x2000, v51
    global_load_lds_dwordx4 v51, s[4:5]
    s_add_u32 m0, s58, 3072
    v_add_u32 v51, 0x2000, v51
    global_load_lds_dwordx4 v51, s[4:5]
    s_waitcnt lgkmcnt(0)
    s_barrier
    ds_read_b128 v[196:199], v232
    s_waitcnt lgkmcnt(0)
    v_min3_u32 v196, v196, v197, v198
    v_min3_u32 v196, v196, v199, s34
    v_lshlrev_b32 v197, 4, v196
    v_sub_u32 v197, s66, v197
    v_mul_u32_u24 v229, v196, v229
    v_mul_u32_u24 v228, v197, v228
    v_cvt_f32_u32 v198, v197
    v_cmp_le_u32 vcc, v229, v228
    v_readfirstlane_b32 s34, v196
    v_mul_f32 v198, v198, v230
    v_sub_u32 v29, v17, v196
    s_ff1_i32_b32 s35, vcc_lo
    v_cvt_u32_f32 v198, v198
    s_min_u32 s35, s35, 9
    s_add_u32 s35, s35, 1
    s_cmp_eq_u32 s34, 0
    s_cselect_b32 s35, 0, s35
    v_readlane_b32 s36, v198, s35
    v_readlane_b32 s38, v231, s35
    s_max_u32 s36, s36, 1
    v_subrev_u32 v17, s36, v29
    v_max_i32 v17, 0, v17
    s_sub_u32 s39, s61, s35
    s_lshl_b32 s39, s39, 2
    v_add_u32_dpp v199, v17, v17 row_shr:1 row_mask:0xf bank_mask:0xf bound_ctrl:0
    v_add_u32_dpp v199, v17, v199 row_shr:2 row_mask:0xf bank_mask:0xf bound_ctrl:0
    v_add_u32_dpp v199, v17, v199 row_shr:3 row_mask:0xf bank_mask:0xf bound_ctrl:0
    s_nop 1
    v_add_u32_dpp v16, v199, v199 row_shr:4 row_mask:0xf bank_mask:0xf bound_ctrl:0
    v_add_u32_dpp v16, v199, v16 row_shr:8 row_mask:0xf bank_mask:0xf bound_ctrl:0
    v_add_u32_dpp v16, v199, v16 row_shr:12 row_mask:0xf bank_mask:0xf bound_ctrl:0
    v_cvt_f32_u32 v198, v16
    v_readlane_b32 s37, v16, 15
    v_mul_f32 v198, s38, v198
    v_cvt_u32_f32 v198, v198
    s_nop 0
    v_readlane_b32 s38, v198, 15
    s_cmp_lt_u32 s63, s35
    s_cbranch_scc1 L_shared
    s_sub_u32 s53, s63, s35
    s_lshl_b32 s53, s53, 2
    s_add_u32 s53, s53, s32
    s_mul_i32 s54, s53, s38
    s_add_u32 s55, s54, s38
    s_lshr_b32 s54, s54, 16
    s_lshr_b32 s55, s55, 16
    s_min_u32 s54, s54, s37
    s_min_u32 s55, s55, s37
    s_add_u32 s53, s53, 1
    s_cmp_ge_u32 s53, s39
    s_cselect_b32 s55, s37, s55
    s_sub_u32 s40, s55, s54
    s_min_u32 s40, s40, 60
    v_add_u32 v22, s54, v2
    v_sub_u32 v23, v16, v17
    v_sub_u32 v24, v22, v23
    v_cmp_lt_u32 vcc, v24, v17
    v_lshl_add_u32 v24, v3, 8, v24
    v_add_lshl_u32 v24, v24, s34, 2
    v_and_b32 v24, 0x3ffc, v24
    ds_read_b32 v25, v24 offset:32768
    s_ff1_i32_b32 s55, vcc_lo
    s_lshr_b32 s56, vcc_lo, 16
    s_ff1_i32_b32 s56, s56
    s_add_u32 s56, s56, 16
    s_waitcnt lgkmcnt(0)
    v_readlane_b32 s43, v25, s55
    v_readlane_b32 s44, v25, s56
    s_lshl_b32 s43, s43, 15
    s_lshl_b32 s44, s44, 15
    s_cmp_gt_u32 s40, 0
    s_cselect_b32 s43, s43, 0x80000000
    s_cmp_gt_u32 s40, 1
    s_cselect_b32 s44, s44, 0x80000000
    s_add_u32 m0, s50, 0
    s_nop 0
    buffer_load_dwordx4 v4, s[20:23], s43 offen nt lds
    s_add_u32 m0, s50, 1024
    s_nop 0
    buffer_load_dwordx4 v5, s[20:23], s43 offen nt lds
    s_add_u32 m0, s50, 2048
    s_nop 0
    buffer_load_dwordx4 v6, s[20:23], s43 offen nt lds
    s_add_u32 m0, s50, 3072
    s_nop 0
    buffer_load_dwordx4 v7, s[20:23], s43 offen nt lds
    buffer_load_dwordx4 v[108:111], v8, s[24:27], s43 offen offset:0 nt
    buffer_load_dwordx4 v[112:115], v8, s[24:27], s43 offen offset:2048 nt
    buffer_load_dwordx4 v[116:119], v9, s[24:27], s43 offen offset:0 nt
    buffer_load_dwordx4 v[120:123], v9, s[24:27], s43 offen offset:2048 nt
    s_mov_b32 s46, 0x3e0293ee
    s_mov_b32 s60, 0x40faf233
    s_mov_b32 s47, 0x05040100
    s_mov_b32 s48, 0x07060302
    v_and_b32 v27, 3, v3
    v_lshlrev_b32 v18, 8, v27
    v_lshl_add_u32 v18, v2, 4, v18
    v_lshlrev_b32 v19, 6, v2
    v_lshl_add_u32 v19, v27, 4, v19
    v_add_u32 v19, 65536, v19
    v_lshlrev_b32 v20, 2, v2
    v_mov_b32 v30, 0x3f803f80
    v_mov_b32 v31, 0x3f803f80
    v_add_u32 v22, s54, v1
    v_mov_b32 v23, 0
    v_mov_b32 v24, 0
    v_readlane_b32 s56, v16, 0
    s_nop 1
    v_cmp_le_u32 vcc, s56, v22
    v_mov_b32 v25, s56
    v_readlane_b32 s55, v16, 1
    v_cndmask_b32 v24, v24, v25, vcc
    v_addc_co_u32 v23, vcc, 0, v23, vcc
    v_cmp_le_u32 vcc, s55, v22
    v_mov_b32 v25, s55
    v_readlane_b32 s56, v16, 2
    v_cndmask_b32 v24, v24, v25, vcc
    v_addc_co_u32 v23, vcc, 0, v23, vcc
    v_cmp_le_u32 vcc, s56, v22
    v_mov_b32 v25, s56
    v_readlane_b32 s55, v16, 3
    v_cndmask_b32 v24, v24, v25, vcc
    v_addc_co_u32 v23, vcc, 0, v23, vcc
    v_cmp_le_u32 vcc, s55, v22
    v_mov_b32 v25, s55
    v_readlane_b32 s56, v16, 4
    v_cndmask_b32 v24, v24, v25, vcc
    v_addc_co_u32 v23, vcc, 0, v23, vcc
    v_cmp_le_u32 vcc, s56, v22
    v_mov_b32 v25, s56
    v_readlane_b32 s55, v16, 5
    v_cndmask_b32 v24, v24, v25, vcc
    v_addc_co_u32 v23, vcc, 0, v23, vcc
    v_cmp_le_u32 vcc, s55, v22
    v_mov_b32 v25, s55
    v_readlane_b32 s56, v16, 6
    v_cndmask_b32 v24, v24, v25, vcc
    v_addc_co_u32 v23, vcc, 0, v23, vcc
    v_cmp_le_u32 vcc, s56, v22
    v_mov_b32 v25, s56
    v_readlane_b32 s55, v16, 7
    v_cndmask_b32 v24, v24, v25, vcc
    v_addc_co_u32 v23, vcc, 0, v23, vcc
    v_cmp_le_u32 vcc, s55, v22
    v_mov_b32 v25, s55
    v_readlane_b32 s56, v16, 8
    v_cndmask_b32 v24, v24, v25, vcc
    v_addc_co_u32 v23, vcc, 0, v23, vcc
    v_cmp_le_u32 vcc, s56, v22
    v_mov_b32 v25, s56
    v_readlane_b32 s55, v16, 9
    v_cndmask_b32 v24, v24, v25, vcc
    v_addc_co_u32 v23, vcc, 0, v23, vcc
    v_cmp_le_u32 vcc, s55, v22
    v_mov_b32 v25, s55
    v_readlane_b32 s56, v16, 10
    v_cndmask_b32 v24, v24, v25, vcc
    v_addc_co_u32 v23, vcc, 0, v23, vcc
    v_cmp_le_u32 vcc, s56, v22
    v_mov_b32 v25, s56
    v_readlane_b32 s55, v16, 11
    v_cndmask_b32 v24, v24, v25, vcc
    v_addc_co_u32 v23, vcc, 0, v23, vcc
    v_cmp_le_u32 vcc, s55, v22
    v_mov_b32 v25, s55
    v_readlane_b32 s56, v16, 12
    v_cndmask_b32 v24, v24, v25, vcc
    v_addc_co_u32 v23, vcc, 0, v23, vcc
    v_cmp_le_u32 vcc, s56, v22
    v_mov_b32 v25, s56
    v_readlane_b32 s55, v16, 13
    v_cndmask_b32 v24, v24, v25, vcc
    v_addc_co_u32 v23, vcc, 0, v23, vcc
    v_cmp_le_u32 vcc, s55, v22
    v_mov_b32 v25, s55
    v_readlane_b32 s56, v16, 14
    v_cndmask_b32 v24, v24, v25, vcc
    v_addc_co_u32 v23, vcc, 0, v23, vcc
    v_cmp_le_u32 vcc, s56, v22
    v_mov_b32 v25, s56
    s_nop 0
    v_cndmask_b32 v24, v24, v25, vcc
    v_addc_co_u32 v23, vcc, 0, v23, vcc
    v_sub_u32 v25, v22, v24
    v_cmp_eq_u32 vcc, 0, v25
    v_add_u32 v25, s34, v25
    v_lshl_add_u32 v26, v23, 8, v25
    s_or_b32 vcc_lo, vcc_lo, 1
    v_lshlrev_b32 v26, 2, v26
    v_and_b32 v26, 0x3ffc, v26
    ds_read_b32 v14, v26 offset:32768
    v_cndmask_b32 v15, 16, 48, vcc
    v_lshl_or_b32 v15, v23, 8, v15
    s_min_u32 s40, s40, 60
    v_cmp_gt_u32 vcc, s40, v1
    v_mov_b32 v22, 0x80000000
    s_waitcnt lgkmcnt(0)
    v_lshlrev_b32 v14, 15, v14
    v_cndmask_b32 v14, v22, v14, vcc
    s_nop 0
    s_and_b32 s53, s33, 3
    s_cmp_eq_u32 s53, 1
    s_cselect_b32 s53, 3, 3
    s_sub_i32 s69, s40, s53
    s_max_i32 s69, s69, 0
    s_waitcnt vmcnt(8)
    s_lshl_b32 s54, s33, 6
    s_add_u32 s54, s54, 0x0
    v_lshlrev_b32 v252, 2, v3
    buffer_load_dword v251, v252, s[28:31], s54 offen
    s_barrier
    s_mov_b32 s65, 0
    s_cmp_eq_u32 s40, 0
    s_cbranch_scc1 L_p_done
L_p_loop:
L_p_pos0:
    s_add_u32 s53, s41, 2
    v_readlane_b32 s42, v15, s41
    v_readlane_b32 s45, v14, s53
    s_waitcnt vmcnt(6)
    s_cmp_ge_u32 s41, s69
    s_cbranch_scc1 L_cwp1
    s_waitcnt vmcnt(4)
L_cwp1:
    s_add_u32 m0, s50, 4096
    s_nop 0
    buffer_load_dwordx4 v4, s[20:23], s44 offen nt lds
    s_add_u32 m0, s50, 5120
    s_nop 0
    buffer_load_dwordx4 v5, s[20:23], s44 offen nt lds
    s_waitcnt vmcnt(6)
    s_cmp_ge_u32 s41, s69
    s_cbranch_scc1 L_cwp2
    s_waitcnt vmcnt(4)
L_cwp2:
    ds_read_b128 v[76:79], v10 offset:0
    ds_read_b128 v[80:83], v11 offset:0
    ds_read_b128 v[84:87], v12 offset:0
    ds_read_b128 v[88:91], v13 offset:0
    s_add_u32 m0, s50, 6144
    s_nop 0
    buffer_load_dwordx4 v6, s[20:23], s44 offen nt lds
    s_add_u32 m0, s50, 7168
    s_nop 0
    buffer_load_dwordx4 v7, s[20:23], s44 offen nt lds
    s_bitcmp1_b32 s42, 5
    s_cbranch_scc1 L_p_seg0
L_p_segret0:
    s_waitcnt lgkmcnt(0)
    v_mfma_f32_16x16x32_bf16 v[52:55], v[76:79], v[140:143], 0
    v_mfma_f32_16x16x32_bf16 v[52:55], v[80:83], v[144:147], v[52:55]
    v_mfma_f32_16x16x32_bf16 v[52:55], v[84:87], v[148:151], v[52:55]
    v_mfma_f32_16x16x32_bf16 v[52:55], v[88:91], v[152:155], v[52:55]
    s_nop 8
    v_max3_f32 v22, v52, v53, v54
    v_max_f32 v22, v22, v55
    v_cmp_gt_f32 vcc, v22, v36
    s_cbranch_vccnz L_p_resc0
L_p_rescret0:
    v_fma_f32 v52, v52, s46, -v32
    v_fma_f32 v53, v53, s46, -v32
    v_fma_f32 v54, v54, s46, -v32
    v_fma_f32 v55, v55, s46, -v32
    v_exp_f32 v52, v52
    v_exp_f32 v53, v53
    v_exp_f32 v54, v54
    v_exp_f32 v55, v55
    v_cvt_pk_bf16_f32 v68, v52, v53
    s_nop 0
    v_cvt_pk_bf16_f32 v69, v54, v55
    s_waitcnt vmcnt(6)
    s_cmp_ge_u32 s41, s69
    s_cbranch_scc1 L_cwp3
    s_waitcnt vmcnt(4)
L_cwp3:
    buffer_load_dwordx4 v[124:127], v8, s[24:27], s44 offen offset:0 nt
    buffer_load_dwordx4 v[128:131], v8, s[24:27], s44 offen offset:2048 nt
    v_mfma_f32_16x16x16_bf16 v[40:43], v[30:31], v[68:69], v[40:43]
    v_perm_b32 v92, v112, v108, s47
    v_perm_b32 v94, v112, v108, s48
    v_perm_b32 v96, v113, v109, s47
    v_perm_b32 v98, v113, v109, s48
    v_perm_b32 v100, v114, v110, s47
    v_perm_b32 v102, v114, v110, s48
    v_perm_b32 v104, v115, v111, s47
    v_perm_b32 v106, v115, v111, s48
    s_waitcnt vmcnt(6)
    s_cmp_ge_u32 s41, s69
    s_cbranch_scc1 L_cwp4
    s_waitcnt vmcnt(4)
L_cwp4:
    buffer_load_dwordx4 v[132:135], v9, s[24:27], s44 offen offset:0 nt
    buffer_load_dwordx4 v[136:139], v9, s[24:27], s44 offen offset:2048 nt
    v_perm_b32 v93, v120, v116, s47
    v_perm_b32 v95, v120, v116, s48
    v_perm_b32 v97, v121, v117, s47
    v_perm_b32 v99, v121, v117, s48
    v_perm_b32 v101, v122, v118, s47
    v_perm_b32 v103, v122, v118, s48
    v_perm_b32 v105, v123, v119, s47
    v_perm_b32 v107, v123, v119, s48
    s_mov_b32 s43, s44
    s_mov_b32 s44, s45
    v_mfma_f32_16x16x16_bf16 v[156:159], v[92:93], v[68:69], v[156:159]
    v_mfma_f32_16x16x16_bf16 v[160:163], v[94:95], v[68:69], v[160:163]
    v_mfma_f32_16x16x16_bf16 v[164:167], v[96:97], v[68:69], v[164:167]
    v_mfma_f32_16x16x16_bf16 v[168:171], v[98:99], v[68:69], v[168:171]
    v_mfma_f32_16x16x16_bf16 v[172:175], v[100:101], v[68:69], v[172:175]
    v_mfma_f32_16x16x16_bf16 v[176:179], v[102:103], v[68:69], v[176:179]
    v_mfma_f32_16x16x16_bf16 v[180:183], v[104:105], v[68:69], v[180:183]
    v_mfma_f32_16x16x16_bf16 v[184:187], v[106:107], v[68:69], v[184:187]
    s_add_u32 s41, s41, 1
    s_cmp_lt_u32 s41, s40
    s_cbranch_scc0 L_p_done
L_p_pos1:
    s_add_u32 s53, s41, 2
    v_readlane_b32 s42, v15, s41
    v_readlane_b32 s45, v14, s53
    s_waitcnt vmcnt(6)
    s_cmp_ge_u32 s41, s69
    s_cbranch_scc1 L_cwp5
    s_waitcnt vmcnt(4)
L_cwp5:
    s_add_u32 m0, s50, 0
    s_nop 0
    buffer_load_dwordx4 v4, s[20:23], s44 offen nt lds
    s_add_u32 m0, s50, 1024
    s_nop 0
    buffer_load_dwordx4 v5, s[20:23], s44 offen nt lds
    s_waitcnt vmcnt(6)
    s_cmp_ge_u32 s41, s69
    s_cbranch_scc1 L_cwp6
    s_waitcnt vmcnt(4)
L_cwp6:
    ds_read_b128 v[76:79], v10 offset:4096
    ds_read_b128 v[80:83], v11 offset:4096
    ds_read_b128 v[84:87], v12 offset:4096
    ds_read_b128 v[88:91], v13 offset:4096
    s_add_u32 m0, s50, 2048
    s_nop 0
    buffer_load_dwordx4 v6, s[20:23], s44 offen nt lds
    s_add_u32 m0, s50, 3072
    s_nop 0
    buffer_load_dwordx4 v7, s[20:23], s44 offen nt lds
    s_bitcmp1_b32 s42, 5
    s_cbranch_scc1 L_p_seg1
L_p_segret1:
    s_waitcnt lgkmcnt(0)
    v_mfma_f32_16x16x32_bf16 v[52:55], v[76:79], v[140:143], 0
    v_mfma_f32_16x16x32_bf16 v[52:55], v[80:83], v[144:147], v[52:55]
    v_mfma_f32_16x16x32_bf16 v[52:55], v[84:87], v[148:151], v[52:55]
    v_mfma_f32_16x16x32_bf16 v[52:55], v[88:91], v[152:155], v[52:55]
    s_nop 8
    v_max3_f32 v22, v52, v53, v54
    v_max_f32 v22, v22, v55
    v_cmp_gt_f32 vcc, v22, v36
    s_cbranch_vccnz L_p_resc1
L_p_rescret1:
    v_fma_f32 v52, v52, s46, -v32
    v_fma_f32 v53, v53, s46, -v32
    v_fma_f32 v54, v54, s46, -v32
    v_fma_f32 v55, v55, s46, -v32
    v_exp_f32 v52, v52
    v_exp_f32 v53, v53
    v_exp_f32 v54, v54
    v_exp_f32 v55, v55
    v_cvt_pk_bf16_f32 v68, v52, v53
    s_nop 0
    v_cvt_pk_bf16_f32 v69, v54, v55
    s_waitcnt vmcnt(6)
    s_cmp_ge_u32 s41, s69
    s_cbranch_scc1 L_cwp7
    s_waitcnt vmcnt(4)
L_cwp7:
    buffer_load_dwordx4 v[108:111], v8, s[24:27], s44 offen offset:0 nt
    buffer_load_dwordx4 v[112:115], v8, s[24:27], s44 offen offset:2048 nt
    v_mfma_f32_16x16x16_bf16 v[40:43], v[30:31], v[68:69], v[40:43]
    v_perm_b32 v92, v128, v124, s47
    v_perm_b32 v94, v128, v124, s48
    v_perm_b32 v96, v129, v125, s47
    v_perm_b32 v98, v129, v125, s48
    v_perm_b32 v100, v130, v126, s47
    v_perm_b32 v102, v130, v126, s48
    v_perm_b32 v104, v131, v127, s47
    v_perm_b32 v106, v131, v127, s48
    s_waitcnt vmcnt(6)
    s_cmp_ge_u32 s41, s69
    s_cbranch_scc1 L_cwp8
    s_waitcnt vmcnt(4)
L_cwp8:
    buffer_load_dwordx4 v[116:119], v9, s[24:27], s44 offen offset:0 nt
    buffer_load_dwordx4 v[120:123], v9, s[24:27], s44 offen offset:2048 nt
    v_perm_b32 v93, v136, v132, s47
    v_perm_b32 v95, v136, v132, s48
    v_perm_b32 v97, v137, v133, s47
    v_perm_b32 v99, v137, v133, s48
    v_perm_b32 v101, v138, v134, s47
    v_perm_b32 v103, v138, v134, s48
    v_perm_b32 v105, v139, v135, s47
    v_perm_b32 v107, v139, v135, s48
    s_mov_b32 s43, s44
    s_mov_b32 s44, s45
    v_mfma_f32_16x16x16_bf16 v[156:159], v[92:93], v[68:69], v[156:159]
    v_mfma_f32_16x16x16_bf16 v[160:163], v[94:95], v[68:69], v[160:163]
    v_mfma_f32_16x16x16_bf16 v[164:167], v[96:97], v[68:69], v[164:167]
    v_mfma_f32_16x16x16_bf16 v[168:171], v[98:99], v[68:69], v[168:171]
    v_mfma_f32_16x16x16_bf16 v[172:175], v[100:101], v[68:69], v[172:175]
    v_mfma_f32_16x16x16_bf16 v[176:179], v[102:103], v[68:69], v[176:179]
    v_mfma_f32_16x16x16_bf16 v[180:183], v[104:105], v[68:69], v[180:183]
    v_mfma_f32_16x16x16_bf16 v[184:187], v[106:107], v[68:69], v[184:187]
    s_add_u32 s41, s41, 1
    s_cmp_lt_u32 s41, s40
    s_cbranch_scc1 L_p_loop
    s_branch L_p_done
L_p_seg0:
    s_call_b64 s[72:73], L_sub_seg
    s_branch L_p_segret0
L_p_resc0:
    s_call_b64 s[72:73], L_sub_resc_p
    s_branch L_p_rescret0
L_p_seg1:
    s_call_b64 s[72:73], L_sub_seg
    s_branch L_p_segret1
L_p_resc1:
    s_call_b64 s[72:73], L_sub_resc_p
    s_branch L_p_rescret1
L_sub_seg:
    s_cmp_eq_u32 s51, 0
    s_cbranch_scc1 L_seg_nof
    s_add_u32 s53, s32, s49
    s_lshl_b32 s53, s53, 11
    v_add_u32 v25, s53, v19
    s_lshl_b32 s53, s49, 5
    s_add_u32 s53, s53, s32
    s_lshl_b32 s53, s53, 3
    s_add_u32 s53, s53, 104448
    v_lshl_add_u32 v26, v1, 6, s53
    v_mov_b32 v33, v40
    s_mov_b32 exec_lo, 0x000f000f
    s_mov_b32 exec_hi, 0x000f000f
    ds_write_b128 v25, v[156:159] offset:0
    ds_write_b128 v25, v[160:163] offset:256
    ds_write_b128 v25, v[164:167] offset:512
    ds_write_b128 v25, v[168:171] offset:768
    ds_write_b128 v25, v[172:175] offset:1024
    ds_write_b128 v25, v[176:179] offset:1280
    ds_write_b128 v25, v[180:183] offset:1536
    ds_write_b128 v25, v[184:187] offset:1792
    s_mov_b64 exec, 15
    ds_write_b64 v26, v[32:33]
    s_mov_b64 exec, -1
L_seg_nof:
    s_mov_b32 s51, 1
    s_bfe_u32 s49, s42, 0x40008
    s_lshl_b32 s53, s49, 10
    v_add_u32 v27, s53, v18
    ds_read_b128 v[140:143], v27 offset:49152
    ds_read_b128 v[144:147], v27 offset:49216
    ds_read_b128 v[148:151], v27 offset:49280
    ds_read_b128 v[152:155], v27 offset:49344
    s_waitcnt lgkmcnt(0)
    v_mov_b32 v156, 0
    v_mov_b32 v157, 0
    v_mov_b32 v158, 0
    v_mov_b32 v159, 0
    v_mov_b32 v160, 0
    v_mov_b32 v161, 0
    v_mov_b32 v162, 0
    v_mov_b32 v163, 0
    v_mov_b32 v164, 0
    v_mov_b32 v165, 0
    v_mov_b32 v166, 0
    v_mov_b32 v167, 0
    v_mov_b32 v168, 0
    v_mov_b32 v169, 0
    v_mov_b32 v170, 0
    v_mov_b32 v171, 0
    v_mov_b32 v172, 0
    v_mov_b32 v173, 0
    v_mov_b32 v174, 0
    v_mov_b32 v175, 0
    v_mov_b32 v176, 0
    v_mov_b32 v177, 0
    v_mov_b32 v178, 0
    v_mov_b32 v179, 0
    v_mov_b32 v180, 0
    v_mov_b32 v181, 0
    v_mov_b32 v182, 0
    v_mov_b32 v183, 0
    v_mov_b32 v184, 0
    v_mov_b32 v185, 0
    v_mov_b32 v186, 0
    v_mov_b32 v187, 0
    v_mov_b32 v40, 0
    v_mov_b32 v41, 0
    v_mov_b32 v42, 0
    v_mov_b32 v43, 0
    v_mov_b32 v32, 0xff7fffff
    v_mov_b32 v36, 0xff800000
    s_bitcmp1_b32 s52, s49
    s_cbranch_scc0 L_seg_ret
    v_mov_b32 v140, 0
    v_mov_b32 v141, 0
    v_mov_b32 v142, 0
    v_mov_b32 v143, 0
    v_mov_b32 v144, 0
    v_mov_b32 v145, 0
    v_mov_b32 v146, 0
    v_mov_b32 v147, 0
    v_mov_b32 v148, 0
    v_mov_b32 v149, 0
    v_mov_b32 v150, 0
    v_mov_b32 v151, 0
    v_mov_b32 v152, 0
    v_mov_b32 v153, 0
    v_mov_b32 v154, 0
    v_mov_b32 v155, 0
    s_nop 1
L_seg_ret:
    s_setpc_b64 s[72:73]
L_p_done:
    s_cmp_eq_u32 s51, 0
    s_cbranch_scc1 L_p_nof
    s_add_u32 s53, s32, s49
    s_lshl_b32 s53, s53, 11
    v_add_u32 v25, s53, v19
    s_lshl_b32 s53, s49, 5
    s_add_u32 s53, s53, s32
    s_lshl_b32 s53, s53, 3
    s_add_u32 s53, s53, 104448
    v_lshl_add_u32 v26, v1, 6, s53
    v_mov_b32 v33, v40
    s_mov_b32 exec_lo, 0x000f000f
    s_mov_b32 exec_hi, 0x000f000f
    ds_write_b128 v25, v[156:159] offset:0
    ds_write_b128 v25, v[160:163] offset:256
    ds_write_b128 v25, v[164:167] offset:512
    ds_write_b128 v25, v[168:171] offset:768
    ds_write_b128 v25, v[172:175] offset:1024
    ds_write_b128 v25, v[176:179] offset:1280
    ds_write_b128 v25, v[180:183] offset:1536
    ds_write_b128 v25, v[184:187] offset:1792
    s_mov_b64 exec, 15
    ds_write_b64 v26, v[32:33]
    s_mov_b64 exec, -1
L_p_nof:
    s_waitcnt vmcnt(0)
    s_mov_b32 s53, 0x9e3779b1
    v_mul_lo_u32 v251, v251, s53
    v_add_u32 v251, 0x7f4a7c15, v251
    s_lshl_b32 s55, s38, 2
    v_and_b32 v46, 31, v1
    v_add_u32 v46, 1, v46
    v_mul_lo_u32 v47, v46, s55
    s_sub_u32 s53, s63, s35
    s_mul_i32 s54, s53, s55
    s_lshr_b32 s54, s54, 16
    s_lshr_b32 s55, s39, 2
    v_lshrrev_b32 v47, 16, v47
    v_cmp_le_u32 vcc, s55, v46
    v_mov_b32 v46, -1
    v_sub_u32 v48, v16, v17
    v_cndmask_b32 v47, v47, v46, vcc
    v_max_u32 v49, s54, v48
    v_readlane_b32 s54, v47, s53
    v_lshlrev_b32 v76, 9, v2
    v_lshl_add_u32 v76, v3, 4, v76
    v_and_b32 v77, 3, v1
    v_lshlrev_b32 v77, 3, v77
    v_lshlrev_b32 v90, 4, v1
    v_min_u32 v50, s54, v16
    v_cmp_lt_u32 vcc, v49, v50
    s_mov_b32 s64, 1
    s_mov_b32 s41, s32
    s_and_b32 s40, vcc_lo, 0xffff
    s_mov_b32 s51, 1
L_help_loop:
    s_cmp_eq_u32 s40, 0
    s_cbranch_scc1 L_help_end
    s_ff1_i32_b32 s49, s40
    s_bitset0_b32 s40, s49
    s_sub_u32 s41, s41, 1
    s_and_b32 s41, s41, 3
    s_cmp_eq_u32 s41, 3
    s_cbranch_scc0 L_help_loop
    v_readlane_b32 s62, v48, s49
    v_readlane_b32 s70, v251, s49
    s_lshl_b32 s53, s49, 8
    s_add_u32 s53, s53, 104448
    v_cmp_ge_u32 vcc, s62, v47
    v_lshl_add_u32 v78, v77, 3, s53
    s_lshl_b32 s53, s49, 11
    s_add_u32 s53, s53, 65536
    v_add_u32 v79, s53, v76
    s_bcnt1_i32_b32 s62, vcc_lo
    s_sub_u32 s62, s63, s62
    s_lshl_b32 s55, s33, 4
    s_add_u32 s55, s55, s49
    s_lshl_b32 s53, s62, 7
    s_add_u32 s53, s53, s55
    s_mul_i32 s53, s53, 3072
    s_add_u32 s53, s53, 0x8000
    s_cmp_eq_u32 s51, 0
    s_cbranch_scc1 L_help_nb
    s_mov_b32 s51, 0
    s_waitcnt lgkmcnt(0)
    s_barrier
L_help_nb:
    ds_read_b128 v[236:239], v78
    ds_read_b128 v[240:243], v78 offset:16
    ds_read_b128 v[156:159], v79 offset:0
    ds_read_b128 v[160:163], v79 offset:256
    ds_read_b128 v[164:167], v79 offset:2048
    ds_read_b128 v[168:171], v79 offset:2304
    ds_read_b128 v[172:175], v79 offset:4096
    ds_read_b128 v[176:179], v79 offset:4352
    ds_read_b128 v[180:183], v79 offset:6144
    ds_read_b128 v[184:187], v79 offset:6400
    s_waitcnt lgkmcnt(8)
    v_max3_f32 v62, v236, v238, v240
    v_max_f32 v62, v62, v242
    v_sub_f32 v80, v236, v62
    v_sub_f32 v81, v238, v62
    v_sub_f32 v82, v240, v62
    v_sub_f32 v83, v242, v62
    v_exp_f32 v80, v80
    v_cmp_lt_f32 s[78:79], 0, v237
    v_exp_f32 v81, v81
    v_cmp_lt_f32 s[80:81], 0, v239
    v_exp_f32 v82, v82
    v_cmp_lt_f32 s[82:83], 0, v241
    v_exp_f32 v83, v83
    v_cmp_lt_f32 s[84:85], 0, v243
    v_mul_f32 v64, v80, v237
    v_fmac_f32 v64, v81, v239
    v_fmac_f32 v64, v82, v241
    v_fmac_f32 v64, v83, v243
    v_rcp_f32 v84, v64
    v_log_f32 v86, v64
    s_waitcnt lgkmcnt(0)
    s_cmp_lg_u64 s[78:79], 0
    s_cbranch_scc1 L_hm_ok0
    v_mov_b32 v156, 0
    v_mov_b32 v157, 0
    v_mov_b32 v158, 0
    v_mov_b32 v159, 0
    v_mov_b32 v160, 0
    v_mov_b32 v161, 0
    v_mov_b32 v162, 0
    v_mov_b32 v163, 0
L_hm_ok0:
    s_cmp_lg_u64 s[80:81], 0
    s_cbranch_scc1 L_hm_ok1
    v_mov_b32 v164, 0
    v_mov_b32 v165, 0
    v_mov_b32 v166, 0
    v_mov_b32 v167, 0
    v_mov_b32 v168, 0
    v_mov_b32 v169, 0
    v_mov_b32 v170, 0
    v_mov_b32 v171, 0
L_hm_ok1:
    s_cmp_lg_u64 s[82:83], 0
    s_cbranch_scc1 L_hm_ok2
    v_mov_b32 v172, 0
    v_mov_b32 v173, 0
    v_mov_b32 v174, 0
    v_mov_b32 v175, 0
    v_mov_b32 v176, 0
    v_mov_b32 v177, 0
    v_mov_b32 v178, 0
    v_mov_b32 v179, 0
L_hm_ok2:
    s_cmp_lg_u64 s[84:85], 0
    s_cbranch_scc1 L_hm_ok3
    v_mov_b32 v180, 0
    v_mov_b32 v181, 0
    v_mov_b32 v182, 0
    v_mov_b32 v183, 0
    v_mov_b32 v184, 0
    v_mov_b32 v185, 0
    v_mov_b32 v186, 0
    v_mov_b32 v187, 0
L_hm_ok3:
    v_pk_mul_f32 v[80:81], v[80:81], v[84:85] op_sel_hi:[1,0]
    v_pk_mul_f32 v[82:83], v[82:83], v[84:85] op_sel_hi:[1,0]
    v_add_f32 v62, v62, v86
    v_mov_b32 v55, s70
    v_pk_mul_f32 v[52:53], v[156:157], v[80:81] op_sel_hi:[1,0]
    v_mul_f32 v54, v162, v80
    v_pk_fma_f32 v[52:53], v[164:165], v[80:81], v[52:53] op_sel:[0,1,0] op_sel_hi:[1,1,1]
    v_fmac_f32 v54, v170, v81
    v_pk_fma_f32 v[52:53], v[172:173], v[82:83], v[52:53] op_sel:[0,0,0] op_sel_hi:[1,0,1]
    v_fmac_f32 v54, v178, v82
    v_pk_fma_f32 v[52:53], v[180:181], v[82:83], v[52:53] op_sel:[0,1,0] op_sel_hi:[1,1,1]
    v_fmac_f32 v54, v186, v83
    s_cmp_eq_u32 s65, 1
    s_cbranch_scc1 L_help_ns0
    buffer_store_dwordx4 v[52:55], v90, s[28:31], s53 offen offset:0 sc1
L_help_ns0:
    v_mov_b32 v59, s70
    v_pk_mul_f32 v[56:57], v[158:159], v[80:81] op_sel_hi:[1,0]
    v_mul_f32 v58, v163, v80
    v_pk_fma_f32 v[56:57], v[166:167], v[80:81], v[56:57] op_sel:[0,1,0] op_sel_hi:[1,1,1]
    v_fmac_f32 v58, v171, v81
    v_pk_fma_f32 v[56:57], v[174:175], v[82:83], v[56:57] op_sel:[0,0,0] op_sel_hi:[1,0,1]
    v_fmac_f32 v58, v179, v82
    v_pk_fma_f32 v[56:57], v[182:183], v[82:83], v[56:57] op_sel:[0,1,0] op_sel_hi:[1,1,1]
    v_fmac_f32 v58, v187, v83
    s_cbranch_scc1 L_help_ns1
    buffer_store_dwordx4 v[56:59], v90, s[28:31], s53 offen offset:1024 sc1
L_help_ns1:
    v_mov_b32 v63, s70
    v_pk_mul_f32 v[60:61], v[160:161], v[80:81] op_sel_hi:[1,0]
    v_pk_fma_f32 v[60:61], v[168:169], v[80:81], v[60:61] op_sel:[0,1,0] op_sel_hi:[1,1,1]
    v_pk_fma_f32 v[60:61], v[176:177], v[82:83], v[60:61] op_sel:[0,0,0] op_sel_hi:[1,0,1]
    v_pk_fma_f32 v[60:61], v[184:185], v[82:83], v[60:61] op_sel:[0,1,0] op_sel_hi:[1,1,1]
    s_cbranch_scc1 L_help_ns2
    buffer_store_dwordx4 v[60:63], v90, s[28:31], s53 offen offset:2048 sc1
L_help_ns2:
    s_call_b64 s[72:73], L_sub_count
    s_call_b64 s[74:75], L_sub_lastcheck
    s_mov_b32 s65, 0
    s_branch L_help_loop
L_help_end:
    s_cmp_eq_u32 s51, 0
    s_cbranch_scc1 L_fin
    s_waitcnt lgkmcnt(0)
    s_barrier
    s_branch L_fin
L_sub_mergelds:
    s_lshl_b32 s53, s69, 8
    s_add_u32 s53, s53, 104448
    v_lshl_add_u32 v78, v77, 3, s53
    ds_read_b128 v[236:239], v78
    ds_read_b128 v[240:243], v78 offset:16
    s_lshl_b32 s53, s69, 11
    s_add_u32 s53, s53, 65536
    v_add_u32 v79, s53, v76
    ds_read_b128 v[156:159], v79 offset:0
    ds_read_b128 v[160:163], v79 offset:256
    ds_read_b128 v[164:167], v79 offset:2048
    ds_read_b128 v[168:171], v79 offset:2304
    ds_read_b128 v[172:175], v79 offset:4096
    ds_read_b128 v[176:179], v79 offset:4352
    ds_read_b128 v[180:183], v79 offset:6144
    ds_read_b128 v[184:187], v79 offset:6400
    s_waitcnt lgkmcnt(8)
    v_cmp_lt_f32 s[78:79], 0, v237
    v_cmp_lt_f32 s[80:81], 0, v239
    v_cmp_lt_f32 s[82:83], 0, v241
    v_cmp_lt_f32 s[84:85], 0, v243
    s_waitcnt lgkmcnt(0)
    s_cmp_lg_u64 s[78:79], 0
    s_cbranch_scc1 L_ml_ok0
    v_mov_b32 v156, 0
    v_mov_b32 v157, 0
    v_mov_b32 v158, 0
    v_mov_b32 v159, 0
    v_mov_b32 v160, 0
    v_mov_b32 v161, 0
    v_mov_b32 v162, 0
    v_mov_b32 v163, 0
L_ml_ok0:
    s_cmp_lg_u64 s[80:81], 0
    s_cbranch_scc1 L_ml_ok1
    v_mov_b32 v164, 0
    v_mov_b32 v165, 0
    v_mov_b32 v166, 0
    v_mov_b32 v167, 0
    v_mov_b32 v168, 0
    v_mov_b32 v169, 0
    v_mov_b32 v170, 0
    v_mov_b32 v171, 0
L_ml_ok1:
    s_cmp_lg_u64 s[82:83], 0
    s_cbranch_scc1 L_ml_ok2
    v_mov_b32 v172, 0
    v_mov_b32 v173, 0
    v_mov_b32 v174, 0
    v_mov_b32 v175, 0
    v_mov_b32 v176, 0
    v_mov_b32 v177, 0
    v_mov_b32 v178, 0
    v_mov_b32 v179, 0
L_ml_ok2:
    s_cmp_lg_u64 s[84:85], 0
    s_cbranch_scc1 L_ml_ok3
    v_mov_b32 v180, 0
    v_mov_b32 v181, 0
    v_mov_b32 v182, 0
    v_mov_b32 v183, 0
    v_mov_b32 v184, 0
    v_mov_b32 v185, 0
    v_mov_b32 v186, 0
    v_mov_b32 v187, 0
L_ml_ok3:
    v_max3_f32 v78, v62, v236, v238
    v_max3_f32 v78, v78, v240, v242
    v_sub_f32 v88, v62, v78
    v_sub_f32 v80, v236, v78
    v_sub_f32 v81, v238, v78
    v_sub_f32 v82, v240, v78
    v_sub_f32 v83, v242, v78
    v_exp_f32 v88, v88
    v_exp_f32 v80, v80
    v_exp_f32 v81, v81
    v_exp_f32 v82, v82
    v_exp_f32 v83, v83
    v_mov_b32 v62, v78
    v_mul_f32 v64, v64, v88
    v_pk_mul_f32 v[52:53], v[52:53], v[88:89] op_sel_hi:[1,0]
    v_pk_mul_f32 v[56:57], v[56:57], v[88:89] op_sel_hi:[1,0]
    v_pk_mul_f32 v[60:61], v[60:61], v[88:89] op_sel_hi:[1,0]
    v_mul_f32 v54, v54, v88
    v_mul_f32 v58, v58, v88
    v_fmac_f32 v64, v237, v80
    v_pk_fma_f32 v[52:53], v[156:157], v[80:81], v[52:53] op_sel:[0,0,0] op_sel_hi:[1,0,1]
    v_pk_fma_f32 v[56:57], v[158:159], v[80:81], v[56:57] op_sel:[0,0,0] op_sel_hi:[1,0,1]
    v_pk_fma_f32 v[60:61], v[160:161], v[80:81], v[60:61] op_sel:[0,0,0] op_sel_hi:[1,0,1]
    v_fmac_f32 v54, v162, v80
    v_fmac_f32 v58, v163, v80
    v_fmac_f32 v64, v239, v81
    v_pk_fma_f32 v[52:53], v[164:165], v[80:81], v[52:53] op_sel:[0,1,0] op_sel_hi:[1,1,1]
    v_pk_fma_f32 v[56:57], v[166:167], v[80:81], v[56:57] op_sel:[0,1,0] op_sel_hi:[1,1,1]
    v_pk_fma_f32 v[60:61], v[168:169], v[80:81], v[60:61] op_sel:[0,1,0] op_sel_hi:[1,1,1]
    v_fmac_f32 v54, v170, v81
    v_fmac_f32 v58, v171, v81
    v_fmac_f32 v64, v241, v82
    v_pk_fma_f32 v[52:53], v[172:173], v[82:83], v[52:53] op_sel:[0,0,0] op_sel_hi:[1,0,1]
    v_pk_fma_f32 v[56:57], v[174:175], v[82:83], v[56:57] op_sel:[0,0,0] op_sel_hi:[1,0,1]
    v_pk_fma_f32 v[60:61], v[176:177], v[82:83], v[60:61] op_sel:[0,0,0] op_sel_hi:[1,0,1]
    v_fmac_f32 v54, v178, v82
    v_fmac_f32 v58, v179, v82
    v_fmac_f32 v64, v243, v83
    v_pk_fma_f32 v[52:53], v[180:181], v[82:83], v[52:53] op_sel:[0,1,0] op_sel_hi:[1,1,1]
    v_pk_fma_f32 v[56:57], v[182:183], v[82:83], v[56:57] op_sel:[0,1,0] op_sel_hi:[1,1,1]
    v_pk_fma_f32 v[60:61], v[184:185], v[82:83], v[60:61] op_sel:[0,1,0] op_sel_hi:[1,1,1]
    v_fmac_f32 v54, v186, v83
    v_fmac_f32 v58, v187, v83
    s_setpc_b64 s[72:73]
L_sub_publish:
    v_max_f32 v64, 0x0da24260, v64
    v_rcp_f32 v80, v64
    v_log_f32 v82, v64
    s_lshl_b32 s55, s33, 4
    s_add_u32 s55, s55, s49
    s_lshl_b32 s53, s62, 7
    s_add_u32 s53, s53, s55
    s_mul_i32 s53, s53, 3072
    s_add_u32 s53, s53, 0x8000
    v_mov_b32 v55, s70
    v_mov_b32 v59, s70
    v_mov_b32 v63, s70
    v_pk_mul_f32 v[52:53], v[52:53], v[80:81] op_sel_hi:[1,0]
    v_pk_mul_f32 v[56:57], v[56:57], v[80:81] op_sel_hi:[1,0]
    v_pk_mul_f32 v[60:61], v[60:61], v[80:81] op_sel_hi:[1,0]
    v_mul_f32 v54, v54, v80
    v_mul_f32 v58, v58, v80
    v_add_f32 v62, v62, v82
    v_mov_b32 v64, 1.0
    buffer_store_dwordx4 v[52:55], v90, s[28:31], s53 offen offset:0 sc1
    buffer_store_dwordx4 v[56:59], v90, s[28:31], s53 offen offset:1024 sc1
    buffer_store_dwordx4 v[60:63], v90, s[28:31], s53 offen offset:2048 sc1
L_sub_count:
    s_and_b32 s56, s49, 1
    s_lshl_b32 s56, s56, 4
    s_lshl_b32 s54, s64, s56
    s_lshr_b32 s55, s55, 1
    s_lshl_b32 s55, s55, 2
    v_mov_b32 v82, s54
    v_mov_b32 v83, s55
    s_waitcnt vmcnt(0)
    s_mov_b64 exec, 1
    global_atomic_add v84, v83, v82, s[16:17] sc0
    s_mov_b64 exec, -1
    s_waitcnt vmcnt(0)
    v_readfirstlane_b32 s65, v84
    s_lshr_b32 s65, s65, s56
    s_and_b32 s65, s65, 0xffff
    s_setpc_b64 s[72:73]
L_sub_lastcheck:
    s_bitcmp1_b32 s65, 8
    s_cbranch_scc0 L_lc_ret
    s_call_b64 s[72:73], L_sub_mask
    s_add_u32 s53, s58, 0xff
    s_cmp_eq_u32 s53, s65
    s_cbranch_scc0 L_lc_ret
    s_bitset1_b32 s57, 31
    v_lshlrev_b32 v76, 9, v2
    v_lshl_add_u32 v76, v3, 4, v76
    v_and_b32 v77, 3, v1
    v_lshlrev_b32 v77, 3, v77
    v_lshlrev_b32 v90, 4, v1
    v_mov_b32 v62, 0xff7fffff
    v_mov_b32 v64, 0
    v_mov_b32 v52, 0
    v_mov_b32 v53, 0
    v_mov_b32 v54, 0
    v_mov_b32 v56, 0
    v_mov_b32 v57, 0
    v_mov_b32 v58, 0
    v_mov_b32 v60, 0
    v_mov_b32 v61, 0
    s_call_b64 s[76:77], L_sub_gather
    s_call_b64 s[72:73], L_sub_out
L_lc_ret:
    s_setpc_b64 s[74:75]
L_sub_out:
    v_rcp_f32 v78, v64
    s_lshl_b32 s53, s49, 13
    s_lshl_b32 s54, s33, 10
    s_add_u32 s53, s53, s54
    v_lshl_add_u32 v79, v77, 5, s53
    v_and_b32 v80, 12, v1
    v_lshl_add_u32 v79, v80, 4, v79
    v_lshl_add_u32 v79, v2, 2, v79
    v_mul_f32 v52, v52, v78
    v_mul_f32 v53, v53, v78
    v_mul_f32 v54, v54, v78
    v_mul_f32 v56, v56, v78
    v_mul_f32 v57, v57, v78
    v_mul_f32 v58, v58, v78
    v_mul_f32 v60, v60, v78
    v_mul_f32 v61, v61, v78
    v_cvt_pk_bf16_f32 v80, v52, v60
    v_cvt_pk_bf16_f32 v81, v53, v61
    v_cvt_pk_bf16_f32 v82, v56, v54
    v_cvt_pk_bf16_f32 v83, v57, v58
    global_store_dword v79, v80, s[14:15] offset:0
    global_store_dword v79, v81, s[14:15] offset:16
    global_store_dword v79, v82, s[14:15] offset:32
    global_store_dword v79, v83, s[14:15] offset:48
    s_lshl_b32 s53, s33, 4
    s_add_u32 s53, s53, s49
    s_lshl_b32 s53, s53, 2
    s_add_u32 s53, s53, 0x0
    v_mov_b32 v84, s53
    v_mov_b32 v85, s70
    s_mov_b64 exec, 1
    global_store_dword v84, v85, s[18:19] sc1
    s_mov_b64 exec, -1
    s_waitcnt vmcnt(0)
    s_setpc_b64 s[72:73]
L_shared:
    s_lshl_b32 s53, s63, 2
    s_add_u32 s53, s53, s32
    s_lshl_b32 s54, s35, 2
    v_mul_u32_u24 v25, s54, v1
    v_add_u32 v25, s53, v25
    v_cmp_gt_u32 vcc, s34, v25
    v_lshlrev_b32 v26, 2, v25
    v_and_b32 v26, 0x3fc, v26
    ds_read_b32 v14, v26 offset:32768
    s_bcnt1_i32_b64 s40, vcc
    s_min_u32 s40, s40, 60
    v_cmp_gt_u32 vcc, s40, v1
    v_mov_b32 v22, 0x80000000
    s_waitcnt lgkmcnt(0)
    v_lshlrev_b32 v14, 15, v14
    v_cndmask_b32 v14, v22, v14, vcc
    s_nop 0
    v_readlane_b32 s43, v14, 0
    v_readlane_b32 s44, v14, 1
    s_nop 2
    s_add_u32 m0, s50, 0
    s_nop 0
    buffer_load_dwordx4 v4, s[20:23], s43 offen nt lds
    s_add_u32 m0, s50, 1024
    s_nop 0
    buffer_load_dwordx4 v5, s[20:23], s43 offen nt lds
    s_add_u32 m0, s50, 2048
    s_nop 0
    buffer_load_dwordx4 v6, s[20:23], s43 offen nt lds
    s_add_u32 m0, s50, 3072
    s_nop 0
    buffer_load_dwordx4 v7, s[20:23], s43 offen nt lds
    buffer_load_dwordx4 v[108:111], v8, s[24:27], s43 offen offset:0 nt
    buffer_load_dwordx4 v[112:115], v8, s[24:27], s43 offen offset:2048 nt
    buffer_load_dwordx4 v[116:119], v9, s[24:27], s43 offen offset:0 nt
    buffer_load_dwordx4 v[120:123], v9, s[24:27], s43 offen offset:2048 nt
    s_mov_b32 s46, 0x3e0293ee
    s_mov_b32 s60, 0x40faf233
    s_mov_b32 s47, 0x05040100
    s_mov_b32 s48, 0x07060302
    v_and_b32 v27, 3, v3
    v_lshlrev_b32 v18, 8, v27
    v_lshl_add_u32 v18, v2, 4, v18
    v_lshlrev_b32 v19, 6, v2
    v_lshl_add_u32 v19, v27, 4, v19
    v_add_u32 v19, 65536, v19
    v_lshlrev_b32 v20, 2, v2
    v_mov_b32 v30, 0x3f803f80
    v_mov_b32 v31, 0x3f803f80
    v_accvgpr_write_b32 a64, 0
    v_accvgpr_write_b32 a65, 0
    v_accvgpr_write_b32 a66, 0
    v_accvgpr_write_b32 a67, 0
    v_accvgpr_write_b32 a68, 0
    v_accvgpr_write_b32 a69, 0
    v_accvgpr_write_b32 a70, 0
    v_accvgpr_write_b32 a71, 0
    v_accvgpr_write_b32 a72, 0
    v_accvgpr_write_b32 a73, 0
    v_accvgpr_write_b32 a74, 0
    v_accvgpr_write_b32 a75, 0
    v_accvgpr_write_b32 a76, 0
    v_accvgpr_write_b32 a77, 0
    v_accvgpr_write_b32 a78, 0
    v_accvgpr_write_b32 a79, 0
    v_accvgpr_write_b32 a80, 0
    v_accvgpr_write_b32 a81, 0
    v_accvgpr_write_b32 a82, 0
    v_accvgpr_write_b32 a83, 0
    v_accvgpr_write_b32 a84, 0
    v_accvgpr_write_b32 a85, 0
    v_accvgpr_write_b32 a86, 0
    v_accvgpr_write_b32 a87, 0
    v_accvgpr_write_b32 a88, 0
    v_accvgpr_write_b32 a89, 0
    v_accvgpr_write_b32 a90, 0
    v_accvgpr_write_b32 a91, 0
    v_accvgpr_write_b32 a92, 0
    v_accvgpr_write_b32 a93, 0
    v_accvgpr_write_b32 a94, 0
    v_accvgpr_write_b32 a95, 0
    v_accvgpr_write_b32 a96, 0
    v_accvgpr_write_b32 a97, 0
    v_accvgpr_write_b32 a98, 0
    v_accvgpr_write_b32 a99, 0
    v_accvgpr_write_b32 a100, 0
    v_accvgpr_write_b32 a101, 0
    v_accvgpr_write_b32 a102, 0
    v_accvgpr_write_b32 a103, 0
    v_accvgpr_write_b32 a104, 0
    v_accvgpr_write_b32 a105, 0
    v_accvgpr_write_b32 a106, 0
    v_accvgpr_write_b32 a107, 0
    v_accvgpr_write_b32 a108, 0
    v_accvgpr_write_b32 a109, 0
    v_accvgpr_write_b32 a110, 0
    v_accvgpr_write_b32 a111, 0
    v_accvgpr_write_b32 a112, 0
    v_accvgpr_write_b32 a113, 0
    v_accvgpr_write_b32 a114, 0
    v_accvgpr_write_b32 a115, 0
    v_accvgpr_write_b32 a116, 0
    v_accvgpr_write_b32 a117, 0
    v_accvgpr_write_b32 a118, 0
    v_accvgpr_write_b32 a119, 0
    v_accvgpr_write_b32 a120, 0
    v_accvgpr_write_b32 a121, 0
    v_accvgpr_write_b32 a122, 0
    v_accvgpr_write_b32 a123, 0
    v_accvgpr_write_b32 a124, 0
    v_accvgpr_write_b32 a125, 0
    v_accvgpr_write_b32 a126, 0
    v_accvgpr_write_b32 a127, 0
    v_accvgpr_write_b32 a128, 0
    v_accvgpr_write_b32 a129, 0
    v_accvgpr_write_b32 a130, 0
    v_accvgpr_write_b32 a131, 0
    v_accvgpr_write_b32 a132, 0
    v_accvgpr_write_b32 a133, 0
    v_accvgpr_write_b32 a134, 0
    v_accvgpr_write_b32 a135, 0
    v_accvgpr_write_b32 a136, 0
    v_accvgpr_write_b32 a137, 0
    v_accvgpr_write_b32 a138, 0
    v_accvgpr_write_b32 a139, 0
    v_accvgpr_write_b32 a140, 0
    v_accvgpr_write_b32 a141, 0
    v_accvgpr_write_b32 a142, 0
    v_accvgpr_write_b32 a143, 0
    v_accvgpr_write_b32 a144, 0
    v_accvgpr_write_b32 a145, 0
    v_accvgpr_write_b32 a146, 0
    v_accvgpr_write_b32 a147, 0
    v_accvgpr_write_b32 a148, 0
    v_accvgpr_write_b32 a149, 0
    v_accvgpr_write_b32 a150, 0
    v_accvgpr_write_b32 a151, 0
    v_accvgpr_write_b32 a152, 0
    v_accvgpr_write_b32 a153, 0
    v_accvgpr_write_b32 a154, 0
    v_accvgpr_write_b32 a155, 0
    v_accvgpr_write_b32 a156, 0
    v_accvgpr_write_b32 a157, 0
    v_accvgpr_write_b32 a158, 0
    v_accvgpr_write_b32 a159, 0
    v_accvgpr_write_b32 a160, 0
    v_accvgpr_write_b32 a161, 0
    v_accvgpr_write_b32 a162, 0
    v_accvgpr_write_b32 a163, 0
    v_accvgpr_write_b32 a164, 0
    v_accvgpr_write_b32 a165, 0
    v_accvgpr_write_b32 a166, 0
    v_accvgpr_write_b32 a167, 0
    v_accvgpr_write_b32 a168, 0
    v_accvgpr_write_b32 a169, 0
    v_accvgpr_write_b32 a170, 0
    v_accvgpr_write_b32 a171, 0
    v_accvgpr_write_b32 a172, 0
    v_accvgpr_write_b32 a173, 0
    v_accvgpr_write_b32 a174, 0
    v_accvgpr_write_b32 a175, 0
    v_accvgpr_write_b32 a176, 0
    v_accvgpr_write_b32 a177, 0
    v_accvgpr_write_b32 a178, 0
    v_accvgpr_write_b32 a179, 0
    v_accvgpr_write_b32 a180, 0
    v_accvgpr_write_b32 a181, 0
    v_accvgpr_write_b32 a182, 0
    v_accvgpr_write_b32 a183, 0
    v_accvgpr_write_b32 a184, 0
    v_accvgpr_write_b32 a185, 0
    v_accvgpr_write_b32 a186, 0
    v_accvgpr_write_b32 a187, 0
    v_accvgpr_write_b32 a188, 0
    v_accvgpr_write_b32 a189, 0
    v_accvgpr_write_b32 a190, 0
    v_accvgpr_write_b32 a191, 0
    v_accvgpr_write_b32 a192, 0
    v_accvgpr_write_b32 a193, 0
    v_accvgpr_write_b32 a194, 0
    v_accvgpr_write_b32 a195, 0
    v_accvgpr_write_b32 a196, 0
    v_accvgpr_write_b32 a197, 0
    v_accvgpr_write_b32 a198, 0
    v_accvgpr_write_b32 a199, 0
    v_accvgpr_write_b32 a200, 0
    v_accvgpr_write_b32 a201, 0
    v_accvgpr_write_b32 a202, 0
    v_accvgpr_write_b32 a203, 0
    v_accvgpr_write_b32 a204, 0
    v_accvgpr_write_b32 a205, 0
    v_accvgpr_write_b32 a206, 0
    v_accvgpr_write_b32 a207, 0
    v_mov_b32 v32, 0xff7fffff
    v_mov_b32 v36, 0xff800000
    v_mov_b32 v33, 0xff7fffff
    v_mov_b32 v37, 0xff800000
    v_mov_b32 v34, 0xff7fffff
    v_mov_b32 v38, 0xff800000
    v_mov_b32 v35, 0xff7fffff
    v_mov_b32 v39, 0xff800000
    v_lshlrev_b32 v22, 8, v3
    v_lshl_add_u32 v22, v2, 4, v22
    s_waitcnt vmcnt(8)
    s_lshl_b32 s54, s33, 6
    s_add_u32 s54, s54, 0x0
    v_lshlrev_b32 v252, 2, v3
    buffer_load_dword v251, v252, s[28:31], s54 offen
    s_barrier
    s_add_u32 s53, s32, 0
    s_and_b32 s53, s53, 3
    s_lshl_b32 s53, s53, 12
    v_add_u32 v23, s53, v22
    ds_read_b128 a[0:3], v23 offset:49152
    ds_read_b128 a[4:7], v23 offset:49216
    ds_read_b128 a[8:11], v23 offset:49280
    ds_read_b128 a[12:15], v23 offset:49344
    s_add_u32 s53, s32, 1
    s_and_b32 s53, s53, 3
    s_lshl_b32 s53, s53, 12
    v_add_u32 v23, s53, v22
    ds_read_b128 a[16:19], v23 offset:49152
    ds_read_b128 a[20:23], v23 offset:49216
    ds_read_b128 a[24:27], v23 offset:49280
    ds_read_b128 a[28:31], v23 offset:49344
    s_add_u32 s53, s32, 2
    s_and_b32 s53, s53, 3
    s_lshl_b32 s53, s53, 12
    v_add_u32 v23, s53, v22
    ds_read_b128 a[32:35], v23 offset:49152
    ds_read_b128 a[36:39], v23 offset:49216
    ds_read_b128 a[40:43], v23 offset:49280
    ds_read_b128 a[44:47], v23 offset:49344
    s_add_u32 s53, s32, 3
    s_and_b32 s53, s53, 3
    s_lshl_b32 s53, s53, 12
    v_add_u32 v23, s53, v22
    ds_read_b128 a[48:51], v23 offset:49152
    ds_read_b128 a[52:55], v23 offset:49216
    ds_read_b128 a[56:59], v23 offset:49280
    ds_read_b128 a[60:63], v23 offset:49344
    s_add_u32 s53, s32, 1
    s_and_b32 s53, s53, 3
    s_mul_i32 s54, s53, 24576
    s_add_u32 s54, s54, 32768
    v_lshl_add_u32 v46, v1, 4, s54
    s_lshl_b32 s54, s53, 11
    s_add_u32 s54, s54, 131584
    v_lshl_add_u32 v49, v1, 3, s54
    s_add_u32 s53, s32, 2
    s_and_b32 s53, s53, 3
    s_mul_i32 s54, s53, 24576
    s_add_u32 s54, s54, 40960
    v_lshl_add_u32 v47, v1, 4, s54
    s_lshl_b32 s54, s53, 11
    s_add_u32 s54, s54, 132096
    v_lshl_add_u32 v50, v1, 3, s54
    s_add_u32 s53, s32, 3
    s_and_b32 s53, s53, 3
    s_mul_i32 s54, s53, 24576
    s_add_u32 s54, s54, 49152
    v_lshl_add_u32 v48, v1, 4, s54
    s_lshl_b32 s54, s53, 11
    s_add_u32 s54, s54, 132608
    v_lshl_add_u32 v51, v1, 3, s54
    s_waitcnt lgkmcnt(0)
    s_barrier
    s_cmp_eq_u32 s40, 0
    s_cbranch_scc1 L_s_done
L_s_loop:
    s_add_u32 s53, s41, 2
    v_readlane_b32 s45, v14, s53
    s_waitcnt vmcnt(6)
    s_add_u32 m0, s50, 4096
    s_nop 0
    buffer_load_dwordx4 v4, s[20:23], s44 offen nt lds
    s_add_u32 m0, s50, 5120
    s_nop 0
    buffer_load_dwordx4 v5, s[20:23], s44 offen nt lds
    s_waitcnt vmcnt(6)
    ds_read_b128 v[76:79], v10 offset:0
    ds_read_b128 v[80:83], v11 offset:0
    ds_read_b128 v[84:87], v12 offset:0
    ds_read_b128 v[88:91], v13 offset:0
    s_add_u32 m0, s50, 6144
    s_nop 0
    buffer_load_dwordx4 v6, s[20:23], s44 offen nt lds
    s_add_u32 m0, s50, 7168
    s_nop 0
    buffer_load_dwordx4 v7, s[20:23], s44 offen nt lds
    s_waitcnt lgkmcnt(3)
    v_mfma_f32_16x16x32_bf16 v[52:55], v[76:79], a[0:3], 0
    s_waitcnt lgkmcnt(2)
    v_mfma_f32_16x16x32_bf16 v[52:55], v[80:83], a[4:7], v[52:55]
    s_waitcnt lgkmcnt(1)
    v_mfma_f32_16x16x32_bf16 v[52:55], v[84:87], a[8:11], v[52:55]
    s_waitcnt lgkmcnt(0)
    v_mfma_f32_16x16x32_bf16 v[52:55], v[88:91], a[12:15], v[52:55]
    v_mfma_f32_16x16x32_bf16 v[56:59], v[76:79], a[16:19], 0
    v_mfma_f32_16x16x32_bf16 v[56:59], v[80:83], a[20:23], v[56:59]
    v_mfma_f32_16x16x32_bf16 v[56:59], v[84:87], a[24:27], v[56:59]
    v_mfma_f32_16x16x32_bf16 v[56:59], v[88:91], a[28:31], v[56:59]
    v_mfma_f32_16x16x32_bf16 v[60:63], v[76:79], a[32:35], 0
    v_mfma_f32_16x16x32_bf16 v[60:63], v[80:83], a[36:39], v[60:63]
    v_mfma_f32_16x16x32_bf16 v[60:63], v[84:87], a[40:43], v[60:63]
    v_mfma_f32_16x16x32_bf16 v[60:63], v[88:91], a[44:47], v[60:63]
    v_mfma_f32_16x16x32_bf16 v[64:67], v[76:79], a[48:51], 0
    v_max3_f32 v22, v52, v53, v54
    v_max_f32 v22, v22, v55
    v_cmp_gt_f32 vcc, v22, v36
    s_cbranch_vccnz L_s_resc0_0
L_s_rescret0_0:
    v_fma_f32 v52, v52, s46, -v32
    v_fma_f32 v53, v53, s46, -v32
    v_fma_f32 v54, v54, s46, -v32
    v_fma_f32 v55, v55, s46, -v32
    v_mfma_f32_16x16x32_bf16 v[64:67], v[80:83], a[52:55], v[64:67]
    v_exp_f32 v52, v52
    v_exp_f32 v53, v53
    v_exp_f32 v54, v54
    v_exp_f32 v55, v55
    v_cvt_pk_bf16_f32 v68, v52, v53
    s_nop 0
    v_cvt_pk_bf16_f32 v69, v54, v55
    v_mfma_f32_16x16x32_bf16 v[64:67], v[84:87], a[56:59], v[64:67]
    v_mfma_f32_16x16x32_bf16 v[64:67], v[88:91], a[60:63], v[64:67]
    s_waitcnt vmcnt(6)
    buffer_load_dwordx4 v[124:127], v8, s[24:27], s44 offen offset:0 nt
    buffer_load_dwordx4 v[128:131], v8, s[24:27], s44 offen offset:2048 nt
    v_perm_b32 v92, v112, v108, s47
    v_perm_b32 v94, v112, v108, s48
    v_perm_b32 v96, v113, v109, s47
    v_perm_b32 v98, v113, v109, s48
    v_perm_b32 v100, v114, v110, s47
    v_perm_b32 v102, v114, v110, s48
    v_perm_b32 v104, v115, v111, s47
    v_perm_b32 v106, v115, v111, s48
    s_waitcnt vmcnt(6)
    buffer_load_dwordx4 v[132:135], v9, s[24:27], s44 offen offset:0 nt
    buffer_load_dwordx4 v[136:139], v9, s[24:27], s44 offen offset:2048 nt
    v_perm_b32 v93, v120, v116, s47
    v_perm_b32 v95, v120, v116, s48
    v_perm_b32 v97, v121, v117, s47
    v_perm_b32 v99, v121, v117, s48
    v_perm_b32 v101, v122, v118, s47
    v_perm_b32 v103, v122, v118, s48
    v_perm_b32 v105, v123, v119, s47
    v_perm_b32 v107, v123, v119, s48
    s_mov_b32 s43, s44
    s_mov_b32 s44, s45
    v_mfma_f32_16x16x16_bf16 a[192:195], v[30:31], v[68:69], a[192:195]
    v_max3_f32 v22, v56, v57, v58
    v_max_f32 v22, v22, v59
    v_mfma_f32_16x16x16_bf16 a[64:67], v[92:93], v[68:69], a[64:67]
    v_cmp_gt_f32 vcc, v22, v37
    s_cbranch_vccnz L_s_resc0_1
L_s_rescret0_1:
    v_fma_f32 v56, v56, s46, -v33
    v_mfma_f32_16x16x16_bf16 a[68:71], v[94:95], v[68:69], a[68:71]
    v_fma_f32 v57, v57, s46, -v33
    v_fma_f32 v58, v58, s46, -v33
    v_mfma_f32_16x16x16_bf16 a[72:75], v[96:97], v[68:69], a[72:75]
    v_fma_f32 v59, v59, s46, -v33
    v_exp_f32 v56, v56
    v_mfma_f32_16x16x16_bf16 a[76:79], v[98:99], v[68:69], a[76:79]
    v_exp_f32 v57, v57
    v_exp_f32 v58, v58
    v_mfma_f32_16x16x16_bf16 a[80:83], v[100:101], v[68:69], a[80:83]
    v_exp_f32 v59, v59
    v_cvt_pk_bf16_f32 v70, v56, v57
    v_mfma_f32_16x16x16_bf16 a[84:87], v[102:103], v[68:69], a[84:87]
    s_nop 0
    v_cvt_pk_bf16_f32 v71, v58, v59
    v_mfma_f32_16x16x16_bf16 a[88:91], v[104:105], v[68:69], a[88:91]
    v_mfma_f32_16x16x16_bf16 a[92:95], v[106:107], v[68:69], a[92:95]
    v_mfma_f32_16x16x16_bf16 a[196:199], v[30:31], v[70:71], a[196:199]
    v_max3_f32 v22, v60, v61, v62
    v_max_f32 v22, v22, v63
    v_mfma_f32_16x16x16_bf16 a[96:99], v[92:93], v[70:71], a[96:99]
    v_cmp_gt_f32 vcc, v22, v38
    s_cbranch_vccnz L_s_resc0_2
L_s_rescret0_2:
    v_fma_f32 v60, v60, s46, -v34
    v_mfma_f32_16x16x16_bf16 a[100:103], v[94:95], v[70:71], a[100:103]
    v_fma_f32 v61, v61, s46, -v34
    v_fma_f32 v62, v62, s46, -v34
    v_mfma_f32_16x16x16_bf16 a[104:107], v[96:97], v[70:71], a[104:107]
    v_fma_f32 v63, v63, s46, -v34
    v_exp_f32 v60, v60
    v_mfma_f32_16x16x16_bf16 a[108:111], v[98:99], v[70:71], a[108:111]
    v_exp_f32 v61, v61
    v_exp_f32 v62, v62
    v_mfma_f32_16x16x16_bf16 a[112:115], v[100:101], v[70:71], a[112:115]
    v_exp_f32 v63, v63
    v_cvt_pk_bf16_f32 v72, v60, v61
    v_mfma_f32_16x16x16_bf16 a[116:119], v[102:103], v[70:71], a[116:119]
    s_nop 0
    v_cvt_pk_bf16_f32 v73, v62, v63
    v_mfma_f32_16x16x16_bf16 a[120:123], v[104:105], v[70:71], a[120:123]
    v_mfma_f32_16x16x16_bf16 a[124:127], v[106:107], v[70:71], a[124:127]
    v_mfma_f32_16x16x16_bf16 a[200:203], v[30:31], v[72:73], a[200:203]
    v_max3_f32 v22, v64, v65, v66
    v_max_f32 v22, v22, v67
    v_mfma_f32_16x16x16_bf16 a[128:131], v[92:93], v[72:73], a[128:131]
    v_cmp_gt_f32 vcc, v22, v39
    s_cbranch_vccnz L_s_resc0_3
L_s_rescret0_3:
    v_fma_f32 v64, v64, s46, -v35
    v_mfma_f32_16x16x16_bf16 a[132:135], v[94:95], v[72:73], a[132:135]
    v_fma_f32 v65, v65, s46, -v35
    v_fma_f32 v66, v66, s46, -v35
    v_mfma_f32_16x16x16_bf16 a[136:139], v[96:97], v[72:73], a[136:139]
    v_fma_f32 v67, v67, s46, -v35
    v_exp_f32 v64, v64
    v_mfma_f32_16x16x16_bf16 a[140:143], v[98:99], v[72:73], a[140:143]
    v_exp_f32 v65, v65
    v_exp_f32 v66, v66
    v_mfma_f32_16x16x16_bf16 a[144:147], v[100:101], v[72:73], a[144:147]
    v_exp_f32 v67, v67
    v_cvt_pk_bf16_f32 v74, v64, v65
    v_mfma_f32_16x16x16_bf16 a[148:151], v[102:103], v[72:73], a[148:151]
    s_nop 0
    v_cvt_pk_bf16_f32 v75, v66, v67
    v_mfma_f32_16x16x16_bf16 a[152:155], v[104:105], v[72:73], a[152:155]
    v_mfma_f32_16x16x16_bf16 a[156:159], v[106:107], v[72:73], a[156:159]
    v_mfma_f32_16x16x16_bf16 a[204:207], v[30:31], v[74:75], a[204:207]
    v_mfma_f32_16x16x16_bf16 a[160:163], v[92:93], v[74:75], a[160:163]
    v_mfma_f32_16x16x16_bf16 a[164:167], v[94:95], v[74:75], a[164:167]
    v_mfma_f32_16x16x16_bf16 a[168:171], v[96:97], v[74:75], a[168:171]
    v_mfma_f32_16x16x16_bf16 a[172:175], v[98:99], v[74:75], a[172:175]
    v_mfma_f32_16x16x16_bf16 a[176:179], v[100:101], v[74:75], a[176:179]
    v_mfma_f32_16x16x16_bf16 a[180:183], v[102:103], v[74:75], a[180:183]
    v_mfma_f32_16x16x16_bf16 a[184:187], v[104:105], v[74:75], a[184:187]
    v_mfma_f32_16x16x16_bf16 a[188:191], v[106:107], v[74:75], a[188:191]
    s_add_u32 s41, s41, 1
    s_cmp_lt_u32 s41, s40
    s_cbranch_scc0 L_s_done
    s_add_u32 s53, s41, 2
    v_readlane_b32 s45, v14, s53
    s_waitcnt vmcnt(6)
    s_add_u32 m0, s50, 0
    s_nop 0
    buffer_load_dwordx4 v4, s[20:23], s44 offen nt lds
    s_add_u32 m0, s50, 1024
    s_nop 0
    buffer_load_dwordx4 v5, s[20:23], s44 offen nt lds
    s_waitcnt vmcnt(6)
    ds_read_b128 v[76:79], v10 offset:4096
    ds_read_b128 v[80:83], v11 offset:4096
    ds_read_b128 v[84:87], v12 offset:4096
    ds_read_b128 v[88:91], v13 offset:4096
    s_add_u32 m0, s50, 2048
    s_nop 0
    buffer_load_dwordx4 v6, s[20:23], s44 offen nt lds
    s_add_u32 m0, s50, 3072
    s_nop 0
    buffer_load_dwordx4 v7, s[20:23], s44 offen nt lds
    s_waitcnt lgkmcnt(3)
    v_mfma_f32_16x16x32_bf16 v[52:55], v[76:79], a[0:3], 0
    s_waitcnt lgkmcnt(2)
    v_mfma_f32_16x16x32_bf16 v[52:55], v[80:83], a[4:7], v[52:55]
    s_waitcnt lgkmcnt(1)
    v_mfma_f32_16x16x32_bf16 v[52:55], v[84:87], a[8:11], v[52:55]
    s_waitcnt lgkmcnt(0)
    v_mfma_f32_16x16x32_bf16 v[52:55], v[88:91], a[12:15], v[52:55]
    v_mfma_f32_16x16x32_bf16 v[56:59], v[76:79], a[16:19], 0
    v_mfma_f32_16x16x32_bf16 v[56:59], v[80:83], a[20:23], v[56:59]
    v_mfma_f32_16x16x32_bf16 v[56:59], v[84:87], a[24:27], v[56:59]
    v_mfma_f32_16x16x32_bf16 v[56:59], v[88:91], a[28:31], v[56:59]
    v_mfma_f32_16x16x32_bf16 v[60:63], v[76:79], a[32:35], 0
    v_mfma_f32_16x16x32_bf16 v[60:63], v[80:83], a[36:39], v[60:63]
    v_mfma_f32_16x16x32_bf16 v[60:63], v[84:87], a[40:43], v[60:63]
    v_mfma_f32_16x16x32_bf16 v[60:63], v[88:91], a[44:47], v[60:63]
    v_mfma_f32_16x16x32_bf16 v[64:67], v[76:79], a[48:51], 0
    v_max3_f32 v22, v52, v53, v54
    v_max_f32 v22, v22, v55
    v_cmp_gt_f32 vcc, v22, v36
    s_cbranch_vccnz L_s_resc1_0
L_s_rescret1_0:
    v_fma_f32 v52, v52, s46, -v32
    v_fma_f32 v53, v53, s46, -v32
    v_fma_f32 v54, v54, s46, -v32
    v_fma_f32 v55, v55, s46, -v32
    v_mfma_f32_16x16x32_bf16 v[64:67], v[80:83], a[52:55], v[64:67]
    v_exp_f32 v52, v52
    v_exp_f32 v53, v53
    v_exp_f32 v54, v54
    v_exp_f32 v55, v55
    v_cvt_pk_bf16_f32 v68, v52, v53
    s_nop 0
    v_cvt_pk_bf16_f32 v69, v54, v55
    v_mfma_f32_16x16x32_bf16 v[64:67], v[84:87], a[56:59], v[64:67]
    v_mfma_f32_16x16x32_bf16 v[64:67], v[88:91], a[60:63], v[64:67]
    s_waitcnt vmcnt(6)
    buffer_load_dwordx4 v[108:111], v8, s[24:27], s44 offen offset:0 nt
    buffer_load_dwordx4 v[112:115], v8, s[24:27], s44 offen offset:2048 nt
    v_perm_b32 v92, v128, v124, s47
    v_perm_b32 v94, v128, v124, s48
    v_perm_b32 v96, v129, v125, s47
    v_perm_b32 v98, v129, v125, s48
    v_perm_b32 v100, v130, v126, s47
    v_perm_b32 v102, v130, v126, s48
    v_perm_b32 v104, v131, v127, s47
    v_perm_b32 v106, v131, v127, s48
    s_waitcnt vmcnt(6)
    buffer_load_dwordx4 v[116:119], v9, s[24:27], s44 offen offset:0 nt
    buffer_load_dwordx4 v[120:123], v9, s[24:27], s44 offen offset:2048 nt
    v_perm_b32 v93, v136, v132, s47
    v_perm_b32 v95, v136, v132, s48
    v_perm_b32 v97, v137, v133, s47
    v_perm_b32 v99, v137, v133, s48
    v_perm_b32 v101, v138, v134, s47
    v_perm_b32 v103, v138, v134, s48
    v_perm_b32 v105, v139, v135, s47
    v_perm_b32 v107, v139, v135, s48
    s_mov_b32 s43, s44
    s_mov_b32 s44, s45
    v_mfma_f32_16x16x16_bf16 a[192:195], v[30:31], v[68:69], a[192:195]
    v_max3_f32 v22, v56, v57, v58
    v_max_f32 v22, v22, v59
    v_mfma_f32_16x16x16_bf16 a[64:67], v[92:93], v[68:69], a[64:67]
    v_cmp_gt_f32 vcc, v22, v37
    s_cbranch_vccnz L_s_resc1_1
L_s_rescret1_1:
    v_fma_f32 v56, v56, s46, -v33
    v_mfma_f32_16x16x16_bf16 a[68:71], v[94:95], v[68:69], a[68:71]
    v_fma_f32 v57, v57, s46, -v33
    v_fma_f32 v58, v58, s46, -v33
    v_mfma_f32_16x16x16_bf16 a[72:75], v[96:97], v[68:69], a[72:75]
    v_fma_f32 v59, v59, s46, -v33
    v_exp_f32 v56, v56
    v_mfma_f32_16x16x16_bf16 a[76:79], v[98:99], v[68:69], a[76:79]
    v_exp_f32 v57, v57
    v_exp_f32 v58, v58
    v_mfma_f32_16x16x16_bf16 a[80:83], v[100:101], v[68:69], a[80:83]
    v_exp_f32 v59, v59
    v_cvt_pk_bf16_f32 v70, v56, v57
    v_mfma_f32_16x16x16_bf16 a[84:87], v[102:103], v[68:69], a[84:87]
    s_nop 0
    v_cvt_pk_bf16_f32 v71, v58, v59
    v_mfma_f32_16x16x16_bf16 a[88:91], v[104:105], v[68:69], a[88:91]
    v_mfma_f32_16x16x16_bf16 a[92:95], v[106:107], v[68:69], a[92:95]
    v_mfma_f32_16x16x16_bf16 a[196:199], v[30:31], v[70:71], a[196:199]
    v_max3_f32 v22, v60, v61, v62
    v_max_f32 v22, v22, v63
    v_mfma_f32_16x16x16_bf16 a[96:99], v[92:93], v[70:71], a[96:99]
    v_cmp_gt_f32 vcc, v22, v38
    s_cbranch_vccnz L_s_resc1_2
L_s_rescret1_2:
    v_fma_f32 v60, v60, s46, -v34
    v_mfma_f32_16x16x16_bf16 a[100:103], v[94:95], v[70:71], a[100:103]
    v_fma_f32 v61, v61, s46, -v34
    v_fma_f32 v62, v62, s46, -v34
    v_mfma_f32_16x16x16_bf16 a[104:107], v[96:97], v[70:71], a[104:107]
    v_fma_f32 v63, v63, s46, -v34
    v_exp_f32 v60, v60
    v_mfma_f32_16x16x16_bf16 a[108:111], v[98:99], v[70:71], a[108:111]
    v_exp_f32 v61, v61
    v_exp_f32 v62, v62
    v_mfma_f32_16x16x16_bf16 a[112:115], v[100:101], v[70:71], a[112:115]
    v_exp_f32 v63, v63
    v_cvt_pk_bf16_f32 v72, v60, v61
    v_mfma_f32_16x16x16_bf16 a[116:119], v[102:103], v[70:71], a[116:119]
    s_nop 0
    v_cvt_pk_bf16_f32 v73, v62, v63
    v_mfma_f32_16x16x16_bf16 a[120:123], v[104:105], v[70:71], a[120:123]
    v_mfma_f32_16x16x16_bf16 a[124:127], v[106:107], v[70:71], a[124:127]
    v_mfma_f32_16x16x16_bf16 a[200:203], v[30:31], v[72:73], a[200:203]
    v_max3_f32 v22, v64, v65, v66
    v_max_f32 v22, v22, v67
    v_mfma_f32_16x16x16_bf16 a[128:131], v[92:93], v[72:73], a[128:131]
    v_cmp_gt_f32 vcc, v22, v39
    s_cbranch_vccnz L_s_resc1_3
L_s_rescret1_3:
    v_fma_f32 v64, v64, s46, -v35
    v_mfma_f32_16x16x16_bf16 a[132:135], v[94:95], v[72:73], a[132:135]
    v_fma_f32 v65, v65, s46, -v35
    v_fma_f32 v66, v66, s46, -v35
    v_mfma_f32_16x16x16_bf16 a[136:139], v[96:97], v[72:73], a[136:139]
    v_fma_f32 v67, v67, s46, -v35
    v_exp_f32 v64, v64
    v_mfma_f32_16x16x16_bf16 a[140:143], v[98:99], v[72:73], a[140:143]
    v_exp_f32 v65, v65
    v_exp_f32 v66, v66
    v_mfma_f32_16x16x16_bf16 a[144:147], v[100:101], v[72:73], a[144:147]
    v_exp_f32 v67, v67
    v_cvt_pk_bf16_f32 v74, v64, v65
    v_mfma_f32_16x16x16_bf16 a[148:151], v[102:103], v[72:73], a[148:151]
    s_nop 0
    v_cvt_pk_bf16_f32 v75, v66, v67
    v_mfma_f32_16x16x16_bf16 a[152:155], v[104:105], v[72:73], a[152:155]
    v_mfma_f32_16x16x16_bf16 a[156:159], v[106:107], v[72:73], a[156:159]
    v_mfma_f32_16x16x16_bf16 a[204:207], v[30:31], v[74:75], a[204:207]
    v_mfma_f32_16x16x16_bf16 a[160:163], v[92:93], v[74:75], a[160:163]
    v_mfma_f32_16x16x16_bf16 a[164:167], v[94:95], v[74:75], a[164:167]
    v_mfma_f32_16x16x16_bf16 a[168:171], v[96:97], v[74:75], a[168:171]
    v_mfma_f32_16x16x16_bf16 a[172:175], v[98:99], v[74:75], a[172:175]
    v_mfma_f32_16x16x16_bf16 a[176:179], v[100:101], v[74:75], a[176:179]
    v_mfma_f32_16x16x16_bf16 a[180:183], v[102:103], v[74:75], a[180:183]
    v_mfma_f32_16x16x16_bf16 a[184:187], v[104:105], v[74:75], a[184:187]
    v_mfma_f32_16x16x16_bf16 a[188:191], v[106:107], v[74:75], a[188:191]
    s_add_u32 s41, s41, 1
    s_cmp_lt_u32 s41, s40
    s_cbranch_scc1 L_s_loop
    s_branch L_s_done
L_s_resc0_0:
    s_call_b64 s[72:73], L_sub_rs0
    s_branch L_s_rescret0_0
L_s_resc0_1:
    s_call_b64 s[72:73], L_sub_rs1
    s_branch L_s_rescret0_1
L_s_resc0_2:
    s_call_b64 s[72:73], L_sub_rs2
    s_branch L_s_rescret0_2
L_s_resc0_3:
    s_call_b64 s[72:73], L_sub_rs3
    s_branch L_s_rescret0_3
L_s_resc1_0:
    s_call_b64 s[72:73], L_sub_rs0
    s_branch L_s_rescret1_0
L_s_resc1_1:
    s_call_b64 s[72:73], L_sub_rs1
    s_branch L_s_rescret1_1
L_s_resc1_2:
    s_call_b64 s[72:73], L_sub_rs2
    s_branch L_s_rescret1_2
L_s_resc1_3:
    s_call_b64 s[72:73], L_sub_rs3
    s_branch L_s_rescret1_3
L_sub_rs0:
    v_mov_b32 v26, v22
    s_nop 1
    v_permlane32_swap_b32 v22, v26
    s_nop 0
    v_max_f32 v22, v22, v26
    v_mov_b32 v26, v22
    s_nop 1
    v_permlane16_swap_b32 v22, v26
    s_nop 0
    v_max_f32 v22, v22, v26
    v_mul_f32 v22, s46, v22
    v_max_f32 v22, v22, v32
    v_sub_f32 v26, v32, v22
    v_exp_f32 v26, v26
    v_mov_b32 v32, v22
    v_add_f32 v24, 0x41000000, v22
    v_mul_f32 v36, s60, v24
    s_cmp_eq_u32 s41, 0
    s_cbranch_scc1 L_sub_rs0_r
    v_accvgpr_read_b32 v140, a64
    v_accvgpr_read_b32 v141, a65
    v_accvgpr_read_b32 v142, a66
    v_accvgpr_read_b32 v143, a67
    v_pk_mul_f32 v[140:141], v[140:141], v[26:27] op_sel_hi:[1,0]
    v_pk_mul_f32 v[142:143], v[142:143], v[26:27] op_sel_hi:[1,0]
    v_accvgpr_write_b32 a64, v140
    v_accvgpr_write_b32 a65, v141
    v_accvgpr_write_b32 a66, v142
    v_accvgpr_write_b32 a67, v143
    v_accvgpr_read_b32 v140, a68
    v_accvgpr_read_b32 v141, a69
    v_accvgpr_read_b32 v142, a70
    v_accvgpr_read_b32 v143, a71
    v_pk_mul_f32 v[140:141], v[140:141], v[26:27] op_sel_hi:[1,0]
    v_pk_mul_f32 v[142:143], v[142:143], v[26:27] op_sel_hi:[1,0]
    v_accvgpr_write_b32 a68, v140
    v_accvgpr_write_b32 a69, v141
    v_accvgpr_write_b32 a70, v142
    v_accvgpr_write_b32 a71, v143
    v_accvgpr_read_b32 v140, a72
    v_accvgpr_read_b32 v141, a73
    v_accvgpr_read_b32 v142, a74
    v_accvgpr_read_b32 v143, a75
    v_pk_mul_f32 v[140:141], v[140:141], v[26:27] op_sel_hi:[1,0]
    v_pk_mul_f32 v[142:143], v[142:143], v[26:27] op_sel_hi:[1,0]
    v_accvgpr_write_b32 a72, v140
    v_accvgpr_write_b32 a73, v141
    v_accvgpr_write_b32 a74, v142
    v_accvgpr_write_b32 a75, v143
    v_accvgpr_read_b32 v140, a76
    v_accvgpr_read_b32 v141, a77
    v_accvgpr_read_b32 v142, a78
    v_accvgpr_read_b32 v143, a79
    v_pk_mul_f32 v[140:141], v[140:141], v[26:27] op_sel_hi:[1,0]
    v_pk_mul_f32 v[142:143], v[142:143], v[26:27] op_sel_hi:[1,0]
    v_accvgpr_write_b32 a76, v140
    v_accvgpr_write_b32 a77, v141
    v_accvgpr_write_b32 a78, v142
    v_accvgpr_write_b32 a79, v143
    v_accvgpr_read_b32 v140, a80
    v_accvgpr_read_b32 v141, a81
    v_accvgpr_read_b32 v142, a82
    v_accvgpr_read_b32 v143, a83
    v_pk_mul_f32 v[140:141], v[140:141], v[26:27] op_sel_hi:[1,0]
    v_pk_mul_f32 v[142:143], v[142:143], v[26:27] op_sel_hi:[1,0]
    v_accvgpr_write_b32 a80, v140
    v_accvgpr_write_b32 a81, v141
    v_accvgpr_write_b32 a82, v142
    v_accvgpr_write_b32 a83, v143
    v_accvgpr_read_b32 v140, a84
    v_accvgpr_read_b32 v141, a85
    v_accvgpr_read_b32 v142, a86
    v_accvgpr_read_b32 v143, a87
    v_pk_mul_f32 v[140:141], v[140:141], v[26:27] op_sel_hi:[1,0]
    v_pk_mul_f32 v[142:143], v[142:143], v[26:27] op_sel_hi:[1,0]
    v_accvgpr_write_b32 a84, v140
    v_accvgpr_write_b32 a85, v141
    v_accvgpr_write_b32 a86, v142
    v_accvgpr_write_b32 a87, v143
    v_accvgpr_read_b32 v140, a88
    v_accvgpr_read_b32 v141, a89
    v_accvgpr_read_b32 v142, a90
    v_accvgpr_read_b32 v143, a91
    v_pk_mul_f32 v[140:141], v[140:141], v[26:27] op_sel_hi:[1,0]
    v_pk_mul_f32 v[142:143], v[142:143], v[26:27] op_sel_hi:[1,0]
    v_accvgpr_write_b32 a88, v140
    v_accvgpr_write_b32 a89, v141
    v_accvgpr_write_b32 a90, v142
    v_accvgpr_write_b32 a91, v143
    v_accvgpr_read_b32 v140, a92
    v_accvgpr_read_b32 v141, a93
    v_accvgpr_read_b32 v142, a94
    v_accvgpr_read_b32 v143, a95
    v_pk_mul_f32 v[140:141], v[140:141], v[26:27] op_sel_hi:[1,0]
    v_pk_mul_f32 v[142:143], v[142:143], v[26:27] op_sel_hi:[1,0]
    v_accvgpr_write_b32 a92, v140
    v_accvgpr_write_b32 a93, v141
    v_accvgpr_write_b32 a94, v142
    v_accvgpr_write_b32 a95, v143
    v_accvgpr_read_b32 v140, a192
    v_accvgpr_read_b32 v141, a193
    v_accvgpr_read_b32 v142, a194
    v_accvgpr_read_b32 v143, a195
    v_pk_mul_f32 v[140:141], v[140:141], v[26:27] op_sel_hi:[1,0]
    v_pk_mul_f32 v[142:143], v[142:143], v[26:27] op_sel_hi:[1,0]
    v_accvgpr_write_b32 a192, v140
    v_accvgpr_write_b32 a193, v141
    v_accvgpr_write_b32 a194, v142
    v_accvgpr_write_b32 a195, v143
L_sub_rs0_r:
    s_setpc_b64 s[72:73]
L_sub_rs1:
    v_mov_b32 v26, v22
    s_nop 1
    v_permlane32_swap_b32 v22, v26
    s_nop 0
    v_max_f32 v22, v22, v26
    v_mov_b32 v26, v22
    s_nop 1
    v_permlane16_swap_b32 v22, v26
    s_nop 0
    v_max_f32 v22, v22, v26
    v_mul_f32 v22, s46, v22
    v_max_f32 v22, v22, v33
    v_sub_f32 v26, v33, v22
    v_exp_f32 v26, v26
    v_mov_b32 v33, v22
    v_add_f32 v24, 0x41000000, v22
    v_mul_f32 v37, s60, v24
    s_cmp_eq_u32 s41, 0
    s_cbranch_scc1 L_sub_rs1_r
    v_accvgpr_read_b32 v140, a96
    v_accvgpr_read_b32 v141, a97
    v_accvgpr_read_b32 v142, a98
    v_accvgpr_read_b32 v143, a99
    v_pk_mul_f32 v[140:141], v[140:141], v[26:27] op_sel_hi:[1,0]
    v_pk_mul_f32 v[142:143], v[142:143], v[26:27] op_sel_hi:[1,0]
    v_accvgpr_write_b32 a96, v140
    v_accvgpr_write_b32 a97, v141
    v_accvgpr_write_b32 a98, v142
    v_accvgpr_write_b32 a99, v143
    v_accvgpr_read_b32 v140, a100
    v_accvgpr_read_b32 v141, a101
    v_accvgpr_read_b32 v142, a102
    v_accvgpr_read_b32 v143, a103
    v_pk_mul_f32 v[140:141], v[140:141], v[26:27] op_sel_hi:[1,0]
    v_pk_mul_f32 v[142:143], v[142:143], v[26:27] op_sel_hi:[1,0]
    v_accvgpr_write_b32 a100, v140
    v_accvgpr_write_b32 a101, v141
    v_accvgpr_write_b32 a102, v142
    v_accvgpr_write_b32 a103, v143
    v_accvgpr_read_b32 v140, a104
    v_accvgpr_read_b32 v141, a105
    v_accvgpr_read_b32 v142, a106
    v_accvgpr_read_b32 v143, a107
    v_pk_mul_f32 v[140:141], v[140:141], v[26:27] op_sel_hi:[1,0]
    v_pk_mul_f32 v[142:143], v[142:143], v[26:27] op_sel_hi:[1,0]
    v_accvgpr_write_b32 a104, v140
    v_accvgpr_write_b32 a105, v141
    v_accvgpr_write_b32 a106, v142
    v_accvgpr_write_b32 a107, v143
    v_accvgpr_read_b32 v140, a108
    v_accvgpr_read_b32 v141, a109
    v_accvgpr_read_b32 v142, a110
    v_accvgpr_read_b32 v143, a111
    v_pk_mul_f32 v[140:141], v[140:141], v[26:27] op_sel_hi:[1,0]
    v_pk_mul_f32 v[142:143], v[142:143], v[26:27] op_sel_hi:[1,0]
    v_accvgpr_write_b32 a108, v140
    v_accvgpr_write_b32 a109, v141
    v_accvgpr_write_b32 a110, v142
    v_accvgpr_write_b32 a111, v143
    v_accvgpr_read_b32 v140, a112
    v_accvgpr_read_b32 v141, a113
    v_accvgpr_read_b32 v142, a114
    v_accvgpr_read_b32 v143, a115
    v_pk_mul_f32 v[140:141], v[140:141], v[26:27] op_sel_hi:[1,0]
    v_pk_mul_f32 v[142:143], v[142:143], v[26:27] op_sel_hi:[1,0]
    v_accvgpr_write_b32 a112, v140
    v_accvgpr_write_b32 a113, v141
    v_accvgpr_write_b32 a114, v142
    v_accvgpr_write_b32 a115, v143
    v_accvgpr_read_b32 v140, a116
    v_accvgpr_read_b32 v141, a117
    v_accvgpr_read_b32 v142, a118
    v_accvgpr_read_b32 v143, a119
    v_pk_mul_f32 v[140:141], v[140:141], v[26:27] op_sel_hi:[1,0]
    v_pk_mul_f32 v[142:143], v[142:143], v[26:27] op_sel_hi:[1,0]
    v_accvgpr_write_b32 a116, v140
    v_accvgpr_write_b32 a117, v141
    v_accvgpr_write_b32 a118, v142
    v_accvgpr_write_b32 a119, v143
    v_accvgpr_read_b32 v140, a120
    v_accvgpr_read_b32 v141, a121
    v_accvgpr_read_b32 v142, a122
    v_accvgpr_read_b32 v143, a123
    v_pk_mul_f32 v[140:141], v[140:141], v[26:27] op_sel_hi:[1,0]
    v_pk_mul_f32 v[142:143], v[142:143], v[26:27] op_sel_hi:[1,0]
    v_accvgpr_write_b32 a120, v140
    v_accvgpr_write_b32 a121, v141
    v_accvgpr_write_b32 a122, v142
    v_accvgpr_write_b32 a123, v143
    v_accvgpr_read_b32 v140, a124
    v_accvgpr_read_b32 v141, a125
    v_accvgpr_read_b32 v142, a126
    v_accvgpr_read_b32 v143, a127
    v_pk_mul_f32 v[140:141], v[140:141], v[26:27] op_sel_hi:[1,0]
    v_pk_mul_f32 v[142:143], v[142:143], v[26:27] op_sel_hi:[1,0]
    v_accvgpr_write_b32 a124, v140
    v_accvgpr_write_b32 a125, v141
    v_accvgpr_write_b32 a126, v142
    v_accvgpr_write_b32 a127, v143
    v_accvgpr_read_b32 v140, a196
    v_accvgpr_read_b32 v141, a197
    v_accvgpr_read_b32 v142, a198
    v_accvgpr_read_b32 v143, a199
    v_pk_mul_f32 v[140:141], v[140:141], v[26:27] op_sel_hi:[1,0]
    v_pk_mul_f32 v[142:143], v[142:143], v[26:27] op_sel_hi:[1,0]
    v_accvgpr_write_b32 a196, v140
    v_accvgpr_write_b32 a197, v141
    v_accvgpr_write_b32 a198, v142
    v_accvgpr_write_b32 a199, v143
L_sub_rs1_r:
    s_setpc_b64 s[72:73]
L_sub_rs2:
    v_mov_b32 v26, v22
    s_nop 1
    v_permlane32_swap_b32 v22, v26
    s_nop 0
    v_max_f32 v22, v22, v26
    v_mov_b32 v26, v22
    s_nop 1
    v_permlane16_swap_b32 v22, v26
    s_nop 0
    v_max_f32 v22, v22, v26
    v_mul_f32 v22, s46, v22
    v_max_f32 v22, v22, v34
    v_sub_f32 v26, v34, v22
    v_exp_f32 v26, v26
    v_mov_b32 v34, v22
    v_add_f32 v24, 0x41000000, v22
    v_mul_f32 v38, s60, v24
    s_cmp_eq_u32 s41, 0
    s_cbranch_scc1 L_sub_rs2_r
    v_accvgpr_read_b32 v140, a128
    v_accvgpr_read_b32 v141, a129
    v_accvgpr_read_b32 v142, a130
    v_accvgpr_read_b32 v143, a131
    v_pk_mul_f32 v[140:141], v[140:141], v[26:27] op_sel_hi:[1,0]
    v_pk_mul_f32 v[142:143], v[142:143], v[26:27] op_sel_hi:[1,0]
    v_accvgpr_write_b32 a128, v140
    v_accvgpr_write_b32 a129, v141
    v_accvgpr_write_b32 a130, v142
    v_accvgpr_write_b32 a131, v143
    v_accvgpr_read_b32 v140, a132
    v_accvgpr_read_b32 v141, a133
    v_accvgpr_read_b32 v142, a134
    v_accvgpr_read_b32 v143, a135
    v_pk_mul_f32 v[140:141], v[140:141], v[26:27] op_sel_hi:[1,0]
    v_pk_mul_f32 v[142:143], v[142:143], v[26:27] op_sel_hi:[1,0]
    v_accvgpr_write_b32 a132, v140
    v_accvgpr_write_b32 a133, v141
    v_accvgpr_write_b32 a134, v142
    v_accvgpr_write_b32 a135, v143
    v_accvgpr_read_b32 v140, a136
    v_accvgpr_read_b32 v141, a137
    v_accvgpr_read_b32 v142, a138
    v_accvgpr_read_b32 v143, a139
    v_pk_mul_f32 v[140:141], v[140:141], v[26:27] op_sel_hi:[1,0]
    v_pk_mul_f32 v[142:143], v[142:143], v[26:27] op_sel_hi:[1,0]
    v_accvgpr_write_b32 a136, v140
    v_accvgpr_write_b32 a137, v141
    v_accvgpr_write_b32 a138, v142
    v_accvgpr_write_b32 a139, v143
    v_accvgpr_read_b32 v140, a140
    v_accvgpr_read_b32 v141, a141
    v_accvgpr_read_b32 v142, a142
    v_accvgpr_read_b32 v143, a143
    v_pk_mul_f32 v[140:141], v[140:141], v[26:27] op_sel_hi:[1,0]
    v_pk_mul_f32 v[142:143], v[142:143], v[26:27] op_sel_hi:[1,0]
    v_accvgpr_write_b32 a140, v140
    v_accvgpr_write_b32 a141, v141
    v_accvgpr_write_b32 a142, v142
    v_accvgpr_write_b32 a143, v143
    v_accvgpr_read_b32 v140, a144
    v_accvgpr_read_b32 v141, a145
    v_accvgpr_read_b32 v142, a146
    v_accvgpr_read_b32 v143, a147
    v_pk_mul_f32 v[140:141], v[140:141], v[26:27] op_sel_hi:[1,0]
    v_pk_mul_f32 v[142:143], v[142:143], v[26:27] op_sel_hi:[1,0]
    v_accvgpr_write_b32 a144, v140
    v_accvgpr_write_b32 a145, v141
    v_accvgpr_write_b32 a146, v142
    v_accvgpr_write_b32 a147, v143
    v_accvgpr_read_b32 v140, a148
    v_accvgpr_read_b32 v141, a149
    v_accvgpr_read_b32 v142, a150
    v_accvgpr_read_b32 v143, a151
    v_pk_mul_f32 v[140:141], v[140:141], v[26:27] op_sel_hi:[1,0]
    v_pk_mul_f32 v[142:143], v[142:143], v[26:27] op_sel_hi:[1,0]
    v_accvgpr_write_b32 a148, v140
    v_accvgpr_write_b32 a149, v141
    v_accvgpr_write_b32 a150, v142
    v_accvgpr_write_b32 a151, v143
    v_accvgpr_read_b32 v140, a152
    v_accvgpr_read_b32 v141, a153
    v_accvgpr_read_b32 v142, a154
    v_accvgpr_read_b32 v143, a155
    v_pk_mul_f32 v[140:141], v[140:141], v[26:27] op_sel_hi:[1,0]
    v_pk_mul_f32 v[142:143], v[142:143], v[26:27] op_sel_hi:[1,0]
    v_accvgpr_write_b32 a152, v140
    v_accvgpr_write_b32 a153, v141
    v_accvgpr_write_b32 a154, v142
    v_accvgpr_write_b32 a155, v143
    v_accvgpr_read_b32 v140, a156
    v_accvgpr_read_b32 v141, a157
    v_accvgpr_read_b32 v142, a158
    v_accvgpr_read_b32 v143, a159
    v_pk_mul_f32 v[140:141], v[140:141], v[26:27] op_sel_hi:[1,0]
    v_pk_mul_f32 v[142:143], v[142:143], v[26:27] op_sel_hi:[1,0]
    v_accvgpr_write_b32 a156, v140
    v_accvgpr_write_b32 a157, v141
    v_accvgpr_write_b32 a158, v142
    v_accvgpr_write_b32 a159, v143
    v_accvgpr_read_b32 v140, a200
    v_accvgpr_read_b32 v141, a201
    v_accvgpr_read_b32 v142, a202
    v_accvgpr_read_b32 v143, a203
    v_pk_mul_f32 v[140:141], v[140:141], v[26:27] op_sel_hi:[1,0]
    v_pk_mul_f32 v[142:143], v[142:143], v[26:27] op_sel_hi:[1,0]
    v_accvgpr_write_b32 a200, v140
    v_accvgpr_write_b32 a201, v141
    v_accvgpr_write_b32 a202, v142
    v_accvgpr_write_b32 a203, v143
L_sub_rs2_r:
    s_setpc_b64 s[72:73]
L_sub_rs3:
    v_mov_b32 v26, v22
    s_nop 1
    v_permlane32_swap_b32 v22, v26
    s_nop 0
    v_max_f32 v22, v22, v26
    v_mov_b32 v26, v22
    s_nop 1
    v_permlane16_swap_b32 v22, v26
    s_nop 0
    v_max_f32 v22, v22, v26
    v_mul_f32 v22, s46, v22
    v_max_f32 v22, v22, v35
    v_sub_f32 v26, v35, v22
    v_exp_f32 v26, v26
    v_mov_b32 v35, v22
    v_add_f32 v24, 0x41000000, v22
    v_mul_f32 v39, s60, v24
    s_cmp_eq_u32 s41, 0
    s_cbranch_scc1 L_sub_rs3_r
    v_accvgpr_read_b32 v140, a160
    v_accvgpr_read_b32 v141, a161
    v_accvgpr_read_b32 v142, a162
    v_accvgpr_read_b32 v143, a163
    v_pk_mul_f32 v[140:141], v[140:141], v[26:27] op_sel_hi:[1,0]
    v_pk_mul_f32 v[142:143], v[142:143], v[26:27] op_sel_hi:[1,0]
    v_accvgpr_write_b32 a160, v140
    v_accvgpr_write_b32 a161, v141
    v_accvgpr_write_b32 a162, v142
    v_accvgpr_write_b32 a163, v143
    v_accvgpr_read_b32 v140, a164
    v_accvgpr_read_b32 v141, a165
    v_accvgpr_read_b32 v142, a166
    v_accvgpr_read_b32 v143, a167
    v_pk_mul_f32 v[140:141], v[140:141], v[26:27] op_sel_hi:[1,0]
    v_pk_mul_f32 v[142:143], v[142:143], v[26:27] op_sel_hi:[1,0]
    v_accvgpr_write_b32 a164, v140
    v_accvgpr_write_b32 a165, v141
    v_accvgpr_write_b32 a166, v142
    v_accvgpr_write_b32 a167, v143
    v_accvgpr_read_b32 v140, a168
    v_accvgpr_read_b32 v141, a169
    v_accvgpr_read_b32 v142, a170
    v_accvgpr_read_b32 v143, a171
    v_pk_mul_f32 v[140:141], v[140:141], v[26:27] op_sel_hi:[1,0]
    v_pk_mul_f32 v[142:143], v[142:143], v[26:27] op_sel_hi:[1,0]
    v_accvgpr_write_b32 a168, v140
    v_accvgpr_write_b32 a169, v141
    v_accvgpr_write_b32 a170, v142
    v_accvgpr_write_b32 a171, v143
    v_accvgpr_read_b32 v140, a172
    v_accvgpr_read_b32 v141, a173
    v_accvgpr_read_b32 v142, a174
    v_accvgpr_read_b32 v143, a175
    v_pk_mul_f32 v[140:141], v[140:141], v[26:27] op_sel_hi:[1,0]
    v_pk_mul_f32 v[142:143], v[142:143], v[26:27] op_sel_hi:[1,0]
    v_accvgpr_write_b32 a172, v140
    v_accvgpr_write_b32 a173, v141
    v_accvgpr_write_b32 a174, v142
    v_accvgpr_write_b32 a175, v143
    v_accvgpr_read_b32 v140, a176
    v_accvgpr_read_b32 v141, a177
    v_accvgpr_read_b32 v142, a178
    v_accvgpr_read_b32 v143, a179
    v_pk_mul_f32 v[140:141], v[140:141], v[26:27] op_sel_hi:[1,0]
    v_pk_mul_f32 v[142:143], v[142:143], v[26:27] op_sel_hi:[1,0]
    v_accvgpr_write_b32 a176, v140
    v_accvgpr_write_b32 a177, v141
    v_accvgpr_write_b32 a178, v142
    v_accvgpr_write_b32 a179, v143
    v_accvgpr_read_b32 v140, a180
    v_accvgpr_read_b32 v141, a181
    v_accvgpr_read_b32 v142, a182
    v_accvgpr_read_b32 v143, a183
    v_pk_mul_f32 v[140:141], v[140:141], v[26:27] op_sel_hi:[1,0]
    v_pk_mul_f32 v[142:143], v[142:143], v[26:27] op_sel_hi:[1,0]
    v_accvgpr_write_b32 a180, v140
    v_accvgpr_write_b32 a181, v141
    v_accvgpr_write_b32 a182, v142
    v_accvgpr_write_b32 a183, v143
    v_accvgpr_read_b32 v140, a184
    v_accvgpr_read_b32 v141, a185
    v_accvgpr_read_b32 v142, a186
    v_accvgpr_read_b32 v143, a187
    v_pk_mul_f32 v[140:141], v[140:141], v[26:27] op_sel_hi:[1,0]
    v_pk_mul_f32 v[142:143], v[142:143], v[26:27] op_sel_hi:[1,0]
    v_accvgpr_write_b32 a184, v140
    v_accvgpr_write_b32 a185, v141
    v_accvgpr_write_b32 a186, v142
    v_accvgpr_write_b32 a187, v143
    v_accvgpr_read_b32 v140, a188
    v_accvgpr_read_b32 v141, a189
    v_accvgpr_read_b32 v142, a190
    v_accvgpr_read_b32 v143, a191
    v_pk_mul_f32 v[140:141], v[140:141], v[26:27] op_sel_hi:[1,0]
    v_pk_mul_f32 v[142:143], v[142:143], v[26:27] op_sel_hi:[1,0]
    v_accvgpr_write_b32 a188, v140
    v_accvgpr_write_b32 a189, v141
    v_accvgpr_write_b32 a190, v142
    v_accvgpr_write_b32 a191, v143
    v_accvgpr_read_b32 v140, a204
    v_accvgpr_read_b32 v141, a205
    v_accvgpr_read_b32 v142, a206
    v_accvgpr_read_b32 v143, a207
    v_pk_mul_f32 v[140:141], v[140:141], v[26:27] op_sel_hi:[1,0]
    v_pk_mul_f32 v[142:143], v[142:143], v[26:27] op_sel_hi:[1,0]
    v_accvgpr_write_b32 a204, v140
    v_accvgpr_write_b32 a205, v141
    v_accvgpr_write_b32 a206, v142
    v_accvgpr_write_b32 a207, v143
L_sub_rs3_r:
    s_setpc_b64 s[72:73]
L_s_done:
    s_lshl_b32 s55, s33, 2
    s_add_u32 s55, s55, s32
    s_waitcnt vmcnt(0)
    s_mov_b32 s53, 0x9e3779b1
    v_mul_lo_u32 v251, v251, s53
    v_add_u32 v251, 0x7f4a7c15, v251
    s_lshl_b32 s53, s32, 4
    v_lshl_add_u32 v44, v2, 2, s53
    ds_bpermute_b32 v45, v44, v251
    s_lshl_b32 s54, s32, 11
    s_add_u32 s54, s54, 131072
    v_lshl_add_u32 v23, v1, 3, s54
    v_lshl_add_u32 v24, v1, 4, s50
    v_mov_b32 v52, v32
    v_accvgpr_read_b32 v53, a192
    v_mov_b32 v54, v33
    v_accvgpr_read_b32 v55, a196
    v_mov_b32 v56, v34
    v_accvgpr_read_b32 v57, a200
    v_mov_b32 v58, v35
    v_accvgpr_read_b32 v59, a204
    ds_write_b64 v23, v[52:53]
    ds_write_b64 v49, v[54:55]
    ds_write_b64 v50, v[56:57]
    ds_write_b64 v51, v[58:59]
    ds_write_b128 v46, a[96:99] offset:0
    ds_write_b128 v46, a[100:103] offset:1024
    ds_write_b128 v46, a[104:107] offset:2048
    ds_write_b128 v46, a[108:111] offset:3072
    ds_write_b128 v46, a[112:115] offset:4096
    ds_write_b128 v46, a[116:119] offset:5120
    ds_write_b128 v46, a[120:123] offset:6144
    ds_write_b128 v46, a[124:127] offset:7168
    ds_write_b128 v47, a[128:131] offset:0
    ds_write_b128 v47, a[132:135] offset:1024
    ds_write_b128 v47, a[136:139] offset:2048
    ds_write_b128 v47, a[140:143] offset:3072
    ds_write_b128 v47, a[144:147] offset:4096
    ds_write_b128 v47, a[148:151] offset:5120
    ds_write_b128 v47, a[152:155] offset:6144
    ds_write_b128 v47, a[156:159] offset:7168
    ds_write_b128 v48, a[160:163] offset:0
    ds_write_b128 v48, a[164:167] offset:1024
    ds_write_b128 v48, a[168:171] offset:2048
    ds_write_b128 v48, a[172:175] offset:3072
    ds_write_b128 v48, a[176:179] offset:4096
    ds_write_b128 v48, a[180:183] offset:5120
    ds_write_b128 v48, a[184:187] offset:6144
    ds_write_b128 v48, a[188:191] offset:7168
    s_waitcnt vmcnt(0)
    ds_write_b128 v24, a[64:67] offset:0
    ds_write_b128 v24, a[68:71] offset:1024
    ds_write_b128 v24, a[72:75] offset:2048
    ds_write_b128 v24, a[76:79] offset:3072
    ds_write_b128 v24, a[80:83] offset:4096
    ds_write_b128 v24, a[84:87] offset:5120
    ds_write_b128 v24, a[88:91] offset:6144
    ds_write_b128 v24, a[92:95] offset:7168
    v_and_b32 v25, 12, v1
    v_and_b32 v26, 3, v1
    v_lshl_add_u32 v26, v25, 2, v26
    v_lshl_add_u32 v26, v2, 2, v26
    v_lshl_add_u32 v23, v26, 3, s54
    v_lshl_add_u32 v24, v26, 4, s50
    s_mul_i32 s53, s32, 24576
    s_add_u32 s53, s53, 32768
    v_lshl_add_u32 v22, v26, 4, s53
    v_mul_u32_u24 v27, 3072, v2
    v_lshl_add_u32 v27, v3, 4, v27
    s_lshl_b32 s59, s63, 5
    s_add_u32 s59, s59, s55
    s_mul_i32 s59, s59, 12288
    s_add_u32 s59, s59, 0x8000
    s_waitcnt lgkmcnt(0)
    v_mov_b32 v195, v45
    v_mov_b32 v199, v45
    v_mov_b32 v203, v45
    v_mov_b32 v207, v45
    v_mov_b32 v211, v45
    v_mov_b32 v215, v45
    v_mov_b32 v219, v45
    v_mov_b32 v223, v45
    v_mov_b32 v227, v45
    v_mov_b32 v231, v45
    v_mov_b32 v235, v45
    v_mov_b32 v239, v45
    s_barrier
    ds_read_b64 v[52:53], v23 offset:0
    ds_read_b64 v[54:55], v23 offset:512
    ds_read_b64 v[56:57], v23 offset:1024
    ds_read_b64 v[58:59], v23 offset:1536
    ds_read_b128 v[128:131], v24 offset:0
    ds_read_b128 v[132:135], v22 offset:0
    ds_read_b128 v[136:139], v22 offset:8192
    ds_read_b128 v[140:143], v22 offset:16384
    ds_read_b128 v[144:147], v24 offset:1024
    ds_read_b128 v[148:151], v22 offset:1024
    ds_read_b128 v[152:155], v22 offset:9216
    ds_read_b128 v[156:159], v22 offset:17408
    s_waitcnt lgkmcnt(8)
    ds_read_b128 v[160:163], v24 offset:2048
    ds_read_b128 v[164:167], v22 offset:2048
    ds_read_b128 v[168:171], v22 offset:10240
    ds_read_b128 v[172:175], v22 offset:18432
    v_max3_f32 v32, v52, v54, v56
    v_max_f32 v32, v32, v58
    v_sub_f32 v60, v52, v32
    v_sub_f32 v61, v54, v32
    v_sub_f32 v62, v56, v32
    v_sub_f32 v63, v58, v32
    v_exp_f32 v60, v60
    v_exp_f32 v61, v61
    v_exp_f32 v62, v62
    v_exp_f32 v63, v63
    v_mul_f32 v33, v53, v60
    v_fmac_f32 v33, v55, v61
    v_fmac_f32 v33, v57, v62
    v_fmac_f32 v33, v59, v63
    v_max_f32 v33, 0x0da24260, v33
    v_rcp_f32 v34, v33
    v_log_f32 v35, v33
    s_nop 0
    v_mul_f32 v60, v60, v34
    v_mul_f32 v61, v61, v34
    v_mul_f32 v62, v62, v34
    v_mul_f32 v63, v63, v34
    v_add_f32 v202, v32, v35
    v_add_f32 v214, v32, v35
    v_add_f32 v226, v32, v35
    v_add_f32 v238, v32, v35
    ds_read_b128 v[176:179], v24 offset:3072
    ds_read_b128 v[180:183], v22 offset:3072
    ds_read_b128 v[184:187], v22 offset:11264
    ds_read_b128 v[188:191], v22 offset:19456
    s_waitcnt lgkmcnt(12)
    v_pk_mul_f32 v[192:193], v[128:129], v[60:61] op_sel_hi:[1,0]
    v_pk_mul_f32 v[196:197], v[130:131], v[60:61] op_sel_hi:[1,0]
    v_pk_fma_f32 v[192:193], v[132:133], v[60:61], v[192:193] op_sel:[0,1,0] op_sel_hi:[1,1,1]
    v_pk_fma_f32 v[196:197], v[134:135], v[60:61], v[196:197] op_sel:[0,1,0] op_sel_hi:[1,1,1]
    v_pk_fma_f32 v[192:193], v[136:137], v[62:63], v[192:193] op_sel:[0,0,0] op_sel_hi:[1,0,1]
    v_pk_fma_f32 v[196:197], v[138:139], v[62:63], v[196:197] op_sel:[0,0,0] op_sel_hi:[1,0,1]
    v_pk_fma_f32 v[192:193], v[140:141], v[62:63], v[192:193] op_sel:[0,1,0] op_sel_hi:[1,1,1]
    v_pk_fma_f32 v[196:197], v[142:143], v[62:63], v[196:197] op_sel:[0,1,0] op_sel_hi:[1,1,1]
    ds_read_b128 v[128:131], v24 offset:4096
    ds_read_b128 v[132:135], v22 offset:4096
    ds_read_b128 v[136:139], v22 offset:12288
    ds_read_b128 v[140:143], v22 offset:20480
    s_waitcnt lgkmcnt(12)
    v_pk_mul_f32 v[200:201], v[144:145], v[60:61] op_sel_hi:[1,0]
    v_mul_f32 v194, v146, v60
    v_mul_f32 v198, v147, v60
    v_pk_fma_f32 v[200:201], v[148:149], v[60:61], v[200:201] op_sel:[0,1,0] op_sel_hi:[1,1,1]
    v_fmac_f32 v194, v150, v61
    v_fmac_f32 v198, v151, v61
    v_pk_fma_f32 v[200:201], v[152:153], v[62:63], v[200:201] op_sel:[0,0,0] op_sel_hi:[1,0,1]
    v_fmac_f32 v194, v154, v62
    v_fmac_f32 v198, v155, v62
    v_pk_fma_f32 v[200:201], v[156:157], v[62:63], v[200:201] op_sel:[0,1,0] op_sel_hi:[1,1,1]
    v_fmac_f32 v194, v158, v63
    v_fmac_f32 v198, v159, v63
    buffer_store_dwordx4 v[192:195], v27, s[28:31], s59 offen offset:0 sc1
    buffer_store_dwordx4 v[196:199], v27, s[28:31], s59 offen offset:1024 sc1
    buffer_store_dwordx4 v[200:203], v27, s[28:31], s59 offen offset:2048 sc1
    ds_read_b128 v[144:147], v24 offset:5120
    ds_read_b128 v[148:151], v22 offset:5120
    ds_read_b128 v[152:155], v22 offset:13312
    ds_read_b128 v[156:159], v22 offset:21504
    s_waitcnt lgkmcnt(12)
    v_pk_mul_f32 v[204:205], v[160:161], v[60:61] op_sel_hi:[1,0]
    v_pk_mul_f32 v[208:209], v[162:163], v[60:61] op_sel_hi:[1,0]
    v_pk_fma_f32 v[204:205], v[164:165], v[60:61], v[204:205] op_sel:[0,1,0] op_sel_hi:[1,1,1]
    v_pk_fma_f32 v[208:209], v[166:167], v[60:61], v[208:209] op_sel:[0,1,0] op_sel_hi:[1,1,1]
    v_pk_fma_f32 v[204:205], v[168:169], v[62:63], v[204:205] op_sel:[0,0,0] op_sel_hi:[1,0,1]
    v_pk_fma_f32 v[208:209], v[170:171], v[62:63], v[208:209] op_sel:[0,0,0] op_sel_hi:[1,0,1]
    v_pk_fma_f32 v[204:205], v[172:173], v[62:63], v[204:205] op_sel:[0,1,0] op_sel_hi:[1,1,1]
    v_pk_fma_f32 v[208:209], v[174:175], v[62:63], v[208:209] op_sel:[0,1,0] op_sel_hi:[1,1,1]
    ds_read_b128 v[160:163], v24 offset:6144
    ds_read_b128 v[164:167], v22 offset:6144
    ds_read_b128 v[168:171], v22 offset:14336
    ds_read_b128 v[172:175], v22 offset:22528
    s_waitcnt lgkmcnt(12)
    v_pk_mul_f32 v[212:213], v[176:177], v[60:61] op_sel_hi:[1,0]
    v_mul_f32 v206, v178, v60
    v_mul_f32 v210, v179, v60
    v_pk_fma_f32 v[212:213], v[180:181], v[60:61], v[212:213] op_sel:[0,1,0] op_sel_hi:[1,1,1]
    v_fmac_f32 v206, v182, v61
    v_fmac_f32 v210, v183, v61
    v_pk_fma_f32 v[212:213], v[184:185], v[62:63], v[212:213] op_sel:[0,0,0] op_sel_hi:[1,0,1]
    v_fmac_f32 v206, v186, v62
    v_fmac_f32 v210, v187, v62
    v_pk_fma_f32 v[212:213], v[188:189], v[62:63], v[212:213] op_sel:[0,1,0] op_sel_hi:[1,1,1]
    v_fmac_f32 v206, v190, v63
    v_fmac_f32 v210, v191, v63
    buffer_store_dwordx4 v[204:207], v27, s[28:31], s59 offen offset:256 sc1
    buffer_store_dwordx4 v[208:211], v27, s[28:31], s59 offen offset:1280 sc1
    buffer_store_dwordx4 v[212:215], v27, s[28:31], s59 offen offset:2304 sc1
    ds_read_b128 v[176:179], v24 offset:7168
    ds_read_b128 v[180:183], v22 offset:7168
    ds_read_b128 v[184:187], v22 offset:15360
    ds_read_b128 v[188:191], v22 offset:23552
    s_waitcnt lgkmcnt(12)
    v_pk_mul_f32 v[216:217], v[128:129], v[60:61] op_sel_hi:[1,0]
    v_pk_mul_f32 v[220:221], v[130:131], v[60:61] op_sel_hi:[1,0]
    v_pk_fma_f32 v[216:217], v[132:133], v[60:61], v[216:217] op_sel:[0,1,0] op_sel_hi:[1,1,1]
    v_pk_fma_f32 v[220:221], v[134:135], v[60:61], v[220:221] op_sel:[0,1,0] op_sel_hi:[1,1,1]
    v_pk_fma_f32 v[216:217], v[136:137], v[62:63], v[216:217] op_sel:[0,0,0] op_sel_hi:[1,0,1]
    v_pk_fma_f32 v[220:221], v[138:139], v[62:63], v[220:221] op_sel:[0,0,0] op_sel_hi:[1,0,1]
    v_pk_fma_f32 v[216:217], v[140:141], v[62:63], v[216:217] op_sel:[0,1,0] op_sel_hi:[1,1,1]
    v_pk_fma_f32 v[220:221], v[142:143], v[62:63], v[220:221] op_sel:[0,1,0] op_sel_hi:[1,1,1]
    s_waitcnt lgkmcnt(8)
    v_pk_mul_f32 v[224:225], v[144:145], v[60:61] op_sel_hi:[1,0]
    v_mul_f32 v218, v146, v60
    v_mul_f32 v222, v147, v60
    v_pk_fma_f32 v[224:225], v[148:149], v[60:61], v[224:225] op_sel:[0,1,0] op_sel_hi:[1,1,1]
    v_fmac_f32 v218, v150, v61
    v_fmac_f32 v222, v151, v61
    v_pk_fma_f32 v[224:225], v[152:153], v[62:63], v[224:225] op_sel:[0,0,0] op_sel_hi:[1,0,1]
    v_fmac_f32 v218, v154, v62
    v_fmac_f32 v222, v155, v62
    v_pk_fma_f32 v[224:225], v[156:157], v[62:63], v[224:225] op_sel:[0,1,0] op_sel_hi:[1,1,1]
    v_fmac_f32 v218, v158, v63
    v_fmac_f32 v222, v159, v63
    buffer_store_dwordx4 v[216:219], v27, s[28:31], s59 offen offset:512 sc1
    buffer_store_dwordx4 v[220:223], v27, s[28:31], s59 offen offset:1536 sc1
    buffer_store_dwordx4 v[224:227], v27, s[28:31], s59 offen offset:2560 sc1
    s_waitcnt lgkmcnt(4)
    v_pk_mul_f32 v[228:229], v[160:161], v[60:61] op_sel_hi:[1,0]
    v_pk_mul_f32 v[232:233], v[162:163], v[60:61] op_sel_hi:[1,0]
    v_pk_fma_f32 v[228:229], v[164:165], v[60:61], v[228:229] op_sel:[0,1,0] op_sel_hi:[1,1,1]
    v_pk_fma_f32 v[232:233], v[166:167], v[60:61], v[232:233] op_sel:[0,1,0] op_sel_hi:[1,1,1]
    v_pk_fma_f32 v[228:229], v[168:169], v[62:63], v[228:229] op_sel:[0,0,0] op_sel_hi:[1,0,1]
    v_pk_fma_f32 v[232:233], v[170:171], v[62:63], v[232:233] op_sel:[0,0,0] op_sel_hi:[1,0,1]
    v_pk_fma_f32 v[228:229], v[172:173], v[62:63], v[228:229] op_sel:[0,1,0] op_sel_hi:[1,1,1]
    v_pk_fma_f32 v[232:233], v[174:175], v[62:63], v[232:233] op_sel:[0,1,0] op_sel_hi:[1,1,1]
    s_waitcnt lgkmcnt(0)
    v_pk_mul_f32 v[236:237], v[176:177], v[60:61] op_sel_hi:[1,0]
    v_mul_f32 v230, v178, v60
    v_mul_f32 v234, v179, v60
    v_pk_fma_f32 v[236:237], v[180:181], v[60:61], v[236:237] op_sel:[0,1,0] op_sel_hi:[1,1,1]
    v_fmac_f32 v230, v182, v61
    v_fmac_f32 v234, v183, v61
    v_pk_fma_f32 v[236:237], v[184:185], v[62:63], v[236:237] op_sel:[0,0,0] op_sel_hi:[1,0,1]
    v_fmac_f32 v230, v186, v62
    v_fmac_f32 v234, v187, v62
    v_pk_fma_f32 v[236:237], v[188:189], v[62:63], v[236:237] op_sel:[0,1,0] op_sel_hi:[1,1,1]
    v_fmac_f32 v230, v190, v63
    v_fmac_f32 v234, v191, v63
    buffer_store_dwordx4 v[228:231], v27, s[28:31], s59 offen offset:768 sc1
    buffer_store_dwordx4 v[232:235], v27, s[28:31], s59 offen offset:1792 sc1
    buffer_store_dwordx4 v[236:239], v27, s[28:31], s59 offen offset:2816 sc1
    s_lshl_b32 s55, s55, 3
    v_lshrrev_b32 v22, 1, v1
    v_lshl_add_u32 v22, v22, 2, s55
    v_and_b32 v23, 1, v1
    v_lshlrev_b32 v23, 4, v23
    v_lshlrev_b32 v24, v23, 1
    s_waitcnt vmcnt(0)
    s_mov_b64 exec, 15
    global_atomic_add v25, v22, v24, s[16:17] sc0
    s_mov_b64 exec, -1
    s_waitcnt vmcnt(0)
    v_lshrrev_b32 v25, v23, v25
    v_and_b32 v15, 0xffff, v25
    s_mov_b32 s41, 0
L_s_lc:
    s_lshl_b32 s49, s32, 2
    s_add_u32 s49, s49, s41
    v_readlane_b32 s65, v15, s41
    v_readlane_b32 s70, v251, s49
    s_call_b64 s[74:75], L_sub_lastcheck
    s_add_u32 s41, s41, 1
    s_cmp_lt_u32 s41, 4
    s_cbranch_scc1 L_s_lc
L_fin:
L_end:
    s_endpgm
.section .rodata,"a"
.p2align 6
.amdhsa_kernel standalone__paged_block_table_kv_radixattention__sampling_kernel
  .amdhsa_next_free_vgpr 464
  .amdhsa_next_free_sgpr 102
  .amdhsa_accum_offset 256
  .amdhsa_group_segment_fixed_size 0
  .amdhsa_kernarg_size 64
  .amdhsa_user_sgpr_count 2
  .amdhsa_user_sgpr_kernarg_segment_ptr 1
  .amdhsa_system_sgpr_workgroup_id_x 1
.end_amdhsa_kernel
```
